```python
import torch

def _softmax(x, axis=-1):
    return torch.softmax(x, dim=axis)

def _gelu(x):
    return torch.nn.functional.gelu(x, approximate='tanh')

def _silu(x):
    return torch.nn.functional.silu(x)

def _sigmoid(x):
    return torch.sigmoid(x)

def _layernorm(x, axis=-1, eps=1e-05):
    m = x.mean(dim=axis, keepdim=True)
    v = x.var(dim=axis, keepdim=True, unbiased=False)
    return (x - m) / torch.sqrt(v + eps)

def _scatter_add(tgt, idx, src, axis=0):
    return tgt.clone().index_add_(axis, idx, src)

def _segment_sum(src, seg, n):
    out = torch.zeros((n,) + src.shape[1:], dtype=src.dtype)
    return out.index_add_(0, seg, src)

def _pad(x, pw):
    flat = tuple((v for pair in reversed(pw) for v in pair))
    return torch.nn.functional.pad(x, flat)
kernel_name = 'standalone__factorization_afm__recsys'

def setup_inputs():

    _w = lambda a: (lambda t: t.to(torch.bfloat16) if t.is_floating_point() else t)(torch.as_tensor(a))
    B, F, D, V = (16384, 26, 32, min(1000000, 100000))
    A = D
    ii, jj = tuple(torch.triu_indices(F, F, 1).unbind(0))
    return {'idx': _w((lambda lo, hi, *s: torch.randint(lo, hi, s))(0, V, B, F).to(torch.int64)), 'table': _w((lambda *s: torch.randn(*s, dtype=torch.bfloat16) * 0.8)(V, D)), 'ii': _w(ii.to(torch.int64)), 'jj': _w(jj.to(torch.int64)), 'W': _w((lambda *s: torch.randn(*s, dtype=torch.bfloat16) * 0.8)(D, A) * (1.0 / D ** 0.5)), 'b': _w((lambda *s: torch.randn(*s, dtype=torch.bfloat16) * 0.8)(A)), 'h': _w((lambda *s: torch.randn(*s, dtype=torch.bfloat16) * 0.8)(A)), 'p': _w((lambda *s: torch.randn(*s, dtype=torch.bfloat16) * 0.2)(D))}

def reference(idx, table, ii, jj, W, b, h, p):
    emb = table[idx]
    ei = emb[:, ii, :].clone()
    ej = emb[:, jj, :].clone()
    pair = ei * ej
    hid = pair @ W + b
    hid = 0.5 * (hid + torch.abs(hid))
    e = hid @ h
    alpha = _softmax(e, axis=-1)
    pooled = torch.einsum('bp,bpd->bd', alpha, pair)
    return pooled @ p
```

```asm
; @launch grid=(256,1,1) block=(512,1,1) lds=68352
.amdgcn_target "amdgcn-amd-amdhsa--gfx950"
.text
.globl standalone__factorization_afm__recsys_kernel
.p2align 8
.type standalone__factorization_afm__recsys_kernel,@function
standalone__factorization_afm__recsys_kernel:
    s_cmp_ge_u32 s2, 256
    s_cbranch_scc1 L_end
    s_load_dwordx4 s[4:7], s[0:1], 0
    s_load_dwordx8 s[8:15], s[0:1], 32
    s_load_dwordx2 s[24:25], s[0:1], 64
    s_getpc_b64 s[54:55]
L_pc:
    s_bfe_u32 s3, s2, 0x20003
    s_mul_i32 s3, s3, 6144
    v_mad_u32_u24 v2, v0, 12, s3
    v_min_u32 v2, L_end-L_pc, v2
    global_load_dword v25, v2, s[54:55]
    v_lshrrev_b32 v1, 6, v0
    v_bfe_u32 v17, v0, 4, 2
    v_readfirstlane_b32 s28, v1
    v_and_b32 v18, 3, v0
    v_bfe_u32 v19, v0, 2, 2
    v_mad_u32_u24 v20, v17, 3, v18
    v_mad_u32_u24 v20, v19, 13, v20
    s_lshl_b32 s3, s2, 3
    s_add_u32 s3, s3, s28
    s_mul_i32 s42, s3, 832
    v_lshl_add_u32 v14, v20, 3, s42
    v_lshlrev_b32 v10, 4, v18
    v_bfe_u32 v16, v0, 5, 1
    v_lshlrev_b32 v18, 4, v16
    s_mov_b32 s22, 6400000
    s_mov_b32 s23, 0x00020000
    s_cmp_ge_u32 s28, 4
    s_cbranch_scc1 L_b1
    s_waitcnt lgkmcnt(0)
    global_load_dwordx2 v[32:33], v14, s[4:5] nt
    s_mov_b32 s20, s6
    s_mov_b32 s21, s7
    s_waitcnt vmcnt(0)
    v_lshlrev_b32 v32, 6, v32
    v_lshlrev_b32 v33, 6, v33
    s_nop 0
    v_add_u32_dpp v11, v32, v10 quad_perm:[0,0,0,0] row_mask:0xf bank_mask:0xf
    buffer_load_dwordx4 v[144:147], v11, s[20:23], 0 offen
    s_nop 0
    v_add_u32_dpp v11, v33, v10 quad_perm:[0,0,0,0] row_mask:0xf bank_mask:0xf
    buffer_load_dwordx4 v[148:151], v11, s[20:23], 0 offen
    s_branch L_c1
L_b1:
    v_and_b32 v17, 19, v0
    v_and_b32 v19, 4, v0
    v_lshl_or_b32 v17, v19, 1, v17
    v_bfe_u32 v19, v0, 3, 1
    v_lshl_or_b32 v17, v19, 2, v17
    v_lshl_or_b32 v19, v17, 6, v18
    v_lshlrev_b32 v17, 1, v17
    s_bitcmp1_b32 s28, 0
    s_cbranch_scc1 L_b1b
    v_bfe_u32 v21, v0, 2, 4
    s_mov_b32 s42, 400000
    v_mad_u32_u24 v21, v21, s42, v10
    s_bitcmp1_b32 s28, 1
    s_waitcnt lgkmcnt(0)
    global_load_dwordx4 v[160:163], v19, s[8:9]
    global_load_dwordx4 v[164:167], v19, s[8:9] offset:32
    s_cbranch_scc0 L_b1h
    global_load_dwordx4 v[128:131], v21, s[6:7]
    global_load_dwordx4 v[168:171], v18, s[12:13]
    global_load_dwordx4 v[172:175], v18, s[12:13] offset:32
    s_branch L_c1
L_b1b:
    s_bitcmp1_b32 s28, 1
    s_waitcnt lgkmcnt(0)
    s_cbranch_scc0 L_b1c
    global_load_dwordx4 v[160:163], v18, s[14:15]
    global_load_dwordx4 v[164:167], v18, s[14:15] offset:32
    s_branch L_c1
L_b1c:
L_b1h:
    global_load_ushort v133, v17, s[10:11]
    global_load_ushort v134, v17, s[12:13]
L_c1:
    s_mov_b32 s20, s6
    s_mov_b32 s21, s7
    s_mov_b32 s29, 0x42100000
    s_mov_b32 s26, 32768
    s_mov_b32 s27, 0x00020000
    s_mul_i32 s43, s28, 7616
    s_movk_i32 s44, 272
    v_and_b32 v17, 15, v0
    v_lshl_add_u32 v17, v17, 4, s43
    v_bfe_u32 v19, v0, 4, 2
    v_mad_u32_u24 v9, v19, s44, v17
    v_lshlrev_b32 v17, 2, v10
    v_bfe_u32 v20, v0, 5, 1
    v_lshlrev_b32 v18, 4, v20
    v_add3_u32 v6, v17, v18, s43
    v_bfe_u32 v17, v0, 2, 3
    v_mad_u32_u24 v1, v17, s44, v6
    v_add_u32 v18, 1, v17
    v_and_b32 v18, 7, v18
    v_mad_u32_u24 v2, v18, s44, v6
    v_add_u32 v18, 3, v17
    v_and_b32 v18, 7, v18
    v_mad_u32_u24 v3, v18, s44, v6
    v_and_b32 v18, 3, v17
    v_mad_u32_u24 v4, v18, s44, v6
    v_add_u32 v19, 2, v17
    v_and_b32 v19, 7, v19
    v_mad_u32_u24 v5, v19, s44, v6
    v_lshrrev_b32 v19, 2, v17
    v_lshl_add_u32 v18, v19, 3, v18
    v_mad_u32_u24 v7, v18, s44, v6
    v_xor_b32 v18, v17, v19
    v_mad_u32_u24 v8, v18, s44, v6
    v_bfe_u32 v17, v0, 4, 1
    v_mul_u32_u24 v18, 368, v20
    v_mad_i32_i24 v17, v17, -5, 17
    v_lshl_add_u32 v17, v17, 2, v18
    v_mov_b32 v18, 416
    s_mov_b32 s40, 0x88888888
    s_mov_b32 s41, s40
    v_cndmask_b32_e64 v26, v18, v17, s[40:41]
    v_mov_b32 v12, 0xdddd
    v_mov_b32 v27, 0xff800000
    s_mov_b32 s40, 0xfff00000
    s_mov_b32 s41, 0xffffffff
    v_cndmask_b32_e64 v13, 0, v27, s[40:41]
    s_mov_b32 s40, 0xf0ff0000
    v_cndmask_b32_e64 v119, 0, v27, s[40:41]
    v_and_b32 v23, 63, v0
    v_lshlrev_b32 v23, 4, v23
    v_add_u32 v23, 60928, v23
    v_xor_b32 v22, 128, v23
    v_mov_b32 v15, 68096
    v_lshl_add_u32 v15, v16, 5, v15
    s_cmp_ge_u32 s28, 4
    s_cbranch_scc1 L_b2
    v_add_u32_dpp v11, v32, v10 quad_perm:[1,1,1,1] row_mask:0xf bank_mask:0xf
    buffer_load_dwordx4 v[152:155], v11, s[20:23], 0 offen
    s_branch L_bar
L_b2:
    v_and_b32 v135, 1, v0
    v_lshlrev_b32 v135, 4, v135
    s_movk_i32 s44, 0x3f80
    v_lshlrev_b32_e64 v21, v135, s44
    s_mov_b32 s32, 0x00030000
    s_mov_b32 s33, 0x00300000
    v_cndmask_b32_e64 v180, 0, v21, s[32:33]
    s_mov_b32 s34, 0x000c0000
    s_mov_b32 s35, 0x00c00000
    v_cndmask_b32_e64 v181, 0, v21, s[34:35]
    s_mov_b32 s36, 0x03000000
    s_mov_b32 s37, 0x30000000
    v_cndmask_b32_e64 v182, 0, v21, s[36:37]
    s_mov_b32 s38, 0x0c000000
    s_mov_b32 s39, 0xc0000000
    v_cndmask_b32_e64 v183, 0, v21, s[38:39]
    s_mov_b32 s32, 0x00000003
    s_mov_b32 s33, 0x00000030
    v_cndmask_b32_e64 v176, 0, v21, s[32:33]
    s_mov_b32 s34, 0x0000000c
    s_mov_b32 s35, 0x000000c0
    v_cndmask_b32_e64 v177, 0, v21, s[34:35]
    s_mov_b32 s36, 0x00000300
    s_mov_b32 s37, 0x00003000
    v_cndmask_b32_e64 v178, 0, v21, s[36:37]
    s_mov_b32 s38, 0x00000c00
    s_mov_b32 s39, 0x0000c000
    v_cndmask_b32_e64 v179, 0, v21, s[38:39]
    s_mov_b32 s52, 0x00300003
    s_mov_b32 s53, s52
    s_cmp_eq_u32 s28, 7
    s_cbranch_scc1 L_p3
    s_cmp_eq_u32 s28, 6
    s_cbranch_scc1 L_p2
    v_and_b32 v17, 31, v0
    v_bfm_b32 v18, v17, 0
    s_waitcnt vmcnt(0)
    v_lshlrev_b32 v134, 16, v134
    v_cmp_gt_i32_e64 vcc, 0, v134
    s_nop 1
    v_and_b32 v18, vcc_lo, v18
    s_bcnt0_i32_b32 s46, vcc_lo
    v_bcnt_u32_b32 v18, v18, 0
    s_and_b32 s47, s46, 1
    v_sub_u32 v17, v17, v18
    v_add_u32 v18, s46, v18
    v_cndmask_b32_e64 v17, v17, v18, vcc
    v_subrev_u32 v17, s47, v17
    v_and_b32 v18, 1, v17
    s_cmp_eq_u32 s28, 5
    s_cbranch_scc1 L_p1
    v_mfma_f32_32x32x16_bf16 v[36:51], v[160:163], v[176:179], 0
    v_bfe_u32 v19, v17, 1, 2
    v_lshl_or_b32 v19, v18, 4, v19
    v_and_b32 v18, 8, v17
    v_mfma_f32_32x32x16_bf16 v[36:51], v[164:167], v[180:183], v[36:51]
    v_or_b32 v19, v19, v18
    v_bfe_u32 v18, v17, 4, 1
    v_lshl_or_b32 v19, v18, 2, v19
    v_and_b32 v18, 0xfffffe00, v23
    v_lshl_add_u32 v24, v19, 4, v18
    v_lshrrev_b32 v17, 15, v133
    v_and_b32 v16, 0x7fffffff, v134
    v_lshl_or_b32 v16, v17, 31, v16
    v_mul_f32 v16, 0x3f392e99, v16
    v_mul_f32 v18, v16, v16
    s_nop 1
    v_pk_mul_f32 v[20:21], v[36:37], v[36:37]
    v_pk_fma_f32 v[20:21], v[38:39], v[38:39], v[20:21]
    v_pk_fma_f32 v[20:21], v[40:41], v[40:41], v[20:21]
    v_pk_fma_f32 v[20:21], v[42:43], v[42:43], v[20:21]
    v_pk_fma_f32 v[20:21], v[44:45], v[44:45], v[20:21]
    v_pk_fma_f32 v[20:21], v[46:47], v[46:47], v[20:21]
    v_pk_fma_f32 v[20:21], v[48:49], v[48:49], v[20:21]
    v_pk_fma_f32 v[20:21], v[50:51], v[50:51], v[20:21]
    v_add_f32 v20, v20, v21
    v_mul_f32 v20, v20, v18
    s_nop 1
    v_add_f32_dpp v20, v20, v20 row_ror:1 row_mask:0xf bank_mask:0xf
    s_nop 1
    v_add_f32_dpp v20, v20, v20 row_ror:2 row_mask:0xf bank_mask:0xf
    s_nop 1
    v_add_f32_dpp v20, v20, v20 row_ror:4 row_mask:0xf bank_mask:0xf
    s_nop 1
    v_add_f32_dpp v20, v20, v20 row_ror:8 row_mask:0xf bank_mask:0xf
    s_nop 1
    v_add_f32_dpp v20, v20, v20 row_bcast:15 row_mask:0xa bank_mask:0xf
    s_nop 1
    v_add_f32_dpp v20, v20, v20 row_bcast:31 row_mask:0xc bank_mask:0xf
    v_mul_f32 v20, 0x3f19999a, v20
    s_nop 0
    v_readlane_b32 s42, v20, 63
    s_nop 1
    s_lshr_b32 s42, s42, 24
    s_sub_i32 s42, 51, s42
    s_add_u32 s43, s42, 40
    s_cmp_gt_u32 s43, 80
    s_cselect_b32 s43, 0x7fc00000, 0
    s_cselect_b32 s42, 0, s42
    v_ldexp_f32 v16, v16, s42
    v_mov_b32 v20, s42
    v_or_b32 v16, s43, v16
    ds_write_b32 v15, v20 offset:144
    v_pk_mul_f32 v[36:37], v[36:37], v[16:17] op_sel:[0,0] op_sel_hi:[1,0]
    v_pk_mul_f32 v[38:39], v[38:39], v[16:17] op_sel:[0,0] op_sel_hi:[1,0]
    v_pk_mul_f32 v[40:41], v[40:41], v[16:17] op_sel:[0,0] op_sel_hi:[1,0]
    v_pk_mul_f32 v[42:43], v[42:43], v[16:17] op_sel:[0,0] op_sel_hi:[1,0]
    v_pk_mul_f32 v[44:45], v[44:45], v[16:17] op_sel:[0,0] op_sel_hi:[1,0]
    v_pk_mul_f32 v[46:47], v[46:47], v[16:17] op_sel:[0,0] op_sel_hi:[1,0]
    v_pk_mul_f32 v[48:49], v[48:49], v[16:17] op_sel:[0,0] op_sel_hi:[1,0]
    v_pk_mul_f32 v[50:51], v[50:51], v[16:17] op_sel:[0,0] op_sel_hi:[1,0]
    v_cvt_pk_f16_f32 v36, v36, v37
    v_cvt_pk_f16_f32 v37, v38, v39
    v_cvt_pk_f16_f32 v38, v40, v41
    v_cvt_pk_f16_f32 v39, v42, v43
    v_cvt_pk_f16_f32 v40, v44, v45
    v_cvt_pk_f16_f32 v41, v46, v47
    v_cvt_pk_f16_f32 v42, v48, v49
    v_cvt_pk_f16_f32 v43, v50, v51
    ds_write_b128 v24, v[36:39]
    ds_write_b128 v24, v[40:43] offset:1024
    s_branch L_bar
L_p2:
    s_waitcnt vmcnt(0)
    v_mfma_f32_32x32x16_bf16 v[36:51], v[160:163], v[168:171], 0
    v_pk_maximum3_f16 v21, v128, v128, 0 neg_lo:[0,1,0] neg_hi:[0,1,0]
    v_pk_maximum3_f16 v21, v129, v129, v21 neg_lo:[0,1,0] neg_hi:[0,1,0]
    v_pk_maximum3_f16 v21, v130, v130, v21 neg_lo:[0,1,0] neg_hi:[0,1,0]
    v_pk_maximum3_f16 v21, v131, v131, v21 neg_lo:[0,1,0] neg_hi:[0,1,0]
    v_max_u32_sdwa v21, v21, v21 dst_sel:DWORD dst_unused:UNUSED_PAD src0_sel:WORD_0 src1_sel:WORD_1
    v_mfma_f32_32x32x16_bf16 v[36:51], v[164:167], v[172:175], v[36:51]
    s_nop 0
    v_max_u32_dpp v21, v21, v21 quad_perm:[1,0,3,2] row_mask:0xf bank_mask:0xf
    s_nop 1
    v_max_u32_dpp v21, v21, v21 quad_perm:[2,3,0,1] row_mask:0xf bank_mask:0xf
    v_add_u32 v21, -1, v21
    s_nop 1
    v_min_u32_dpp v21, v21, v21 row_ror:4 row_mask:0xf bank_mask:0xf
    s_nop 1
    v_min_u32_dpp v21, v21, v21 row_ror:8 row_mask:0xf bank_mask:0xf
    s_nop 0
    v_readlane_b32 s42, v21, 0
    v_readlane_b32 s43, v21, 16
    v_readlane_b32 s44, v21, 32
    v_readlane_b32 s45, v21, 48
    s_min_u32 s42, s42, s43
    s_nop 0
    s_min_u32 s44, s44, s45
    s_min_u32 s44, s44, s42
    s_add_u32 s44, s44, 1
    s_bfe_u32 s44, s44, 0x80007
    s_sub_i32 s42, 120, s44
    s_min_i32 s42, s42, 40
    s_cmp_lt_i32 s42, -40
    s_cselect_b32 s42, 40, s42
    s_lshl_b32 s43, s42, 24
    s_sub_u32 s44, 0x3f38aa3b, s43
    v_mov_b32 v18, s44
    s_add_i32 s44, s42, 127
    s_lshl_b32 s44, s44, 7
    v_cndmask_b32_e64 v18, 0, v18, s[52:53]
    v_lshlrev_b32_e64 v21, v135, s44
    v_mov_b32 v20, s42
    s_mov_b32 s40, 0xcccccccc
    s_mov_b32 s41, s40
    v_cndmask_b32_e64 v52, v21, 0, s[40:41]
    v_cndmask_b32_e64 v53, 0, v21, s[40:41]
    ds_write_b32 v15, v20 offset:136
    ds_write_b64 v23, v[52:53] offset:5120
    v_pk_mul_f32 v[36:37], v[36:37], v[18:19] op_sel:[0,0] op_sel_hi:[1,0]
    v_pk_mul_f32 v[38:39], v[38:39], v[18:19] op_sel:[0,0] op_sel_hi:[1,0]
    v_pk_mul_f32 v[40:41], v[40:41], v[18:19] op_sel:[0,0] op_sel_hi:[1,0]
    v_pk_mul_f32 v[42:43], v[42:43], v[18:19] op_sel:[0,0] op_sel_hi:[1,0]
    v_pk_mul_f32 v[44:45], v[44:45], v[18:19] op_sel:[0,0] op_sel_hi:[1,0]
    v_pk_mul_f32 v[46:47], v[46:47], v[18:19] op_sel:[0,0] op_sel_hi:[1,0]
    v_pk_mul_f32 v[48:49], v[48:49], v[18:19] op_sel:[0,0] op_sel_hi:[1,0]
    v_pk_mul_f32 v[50:51], v[50:51], v[18:19] op_sel:[0,0] op_sel_hi:[1,0]
    v_cvt_pk_f16_f32 v36, v36, v37
    v_cvt_pk_f16_f32 v37, v38, v39
    v_cvt_pk_f16_f32 v38, v40, v41
    v_cvt_pk_f16_f32 v39, v42, v43
    v_cvt_pk_f16_f32 v40, v44, v45
    v_cvt_pk_f16_f32 v41, v46, v47
    v_cvt_pk_f16_f32 v42, v48, v49
    v_cvt_pk_f16_f32 v43, v50, v51
    s_mov_b32 exec_lo, 0x55555555
    s_mov_b32 exec_hi, exec_lo
    ds_write_b128 v23, v[36:39] offset:2048
    ds_write_b128 v23, v[40:43] offset:3072
    s_mov_b64 exec, -1
    s_branch L_bar
L_p1:
    v_bfe_u32 v19, v17, 1, 4
    v_lshl_or_b32 v19, v18, 4, v19
    v_lshlrev_b32 v19, 2, v19
    v_lshlrev_b32 v133, 16, v133
    v_add_u32 v19, 68096, v19
    v_mul_f32_e64 v133, |v133|, |v134|
    s_lshr_b32 s46, s46, 1
    v_mul_f32 v133, 0x3f392e99, v133
    v_add_u32 v133, 2048, v133
    v_and_b32 v133, 0xfffff000, v133
    s_lshl_b32 s46, -1, s46
    s_lshl_b32 s45, s47, 15
    s_andn2_b32 s46, s46, s45
    ds_write_b32 v19, v133
    v_and_b32 v17, s47, v16
    v_lshl_or_b32 v17, v17, 31, 1.0
    v_bfe_u32 v18, v0, 4, 1
    v_lshl_or_b32 v18, v18, 1, v16
    v_lshlrev_b32 v18, 2, v18
    ds_write_b32 v15, v17 offset:128
    v_lshrrev_b32_e64 v18, v18, s46
    s_mov_b32 s44, 0x7f807f80
    v_bfe_u32 v19, v18, 0, 1
    v_bfe_u32 v20, v18, 1, 1
    v_lshl_or_b32 v19, v19, 15, s44
    v_lshl_or_b32 v36, v20, 31, v19
    v_bfe_u32 v19, v18, 2, 1
    v_bfe_u32 v20, v18, 3, 1
    v_lshl_or_b32 v19, v19, 15, s44
    v_lshl_or_b32 v37, v20, 31, v19
    s_mov_b32 s40, 0x00010001
    s_mov_b32 s41, s40
    v_cndmask_b32_e64 v52, 0, v36, s[40:41]
    v_cndmask_b32_e64 v53, 0, v37, s[40:41]
    s_mov_b32 s40, 0x00100010
    s_mov_b32 s41, s40
    v_cndmask_b32_e64 v54, 0, v36, s[40:41]
    v_cndmask_b32_e64 v55, 0, v37, s[40:41]
    ds_write_b128 v23, v[52:55] offset:4096
    s_mov_b32 s40, 0x02000200
    s_mov_b32 s41, s40
    v_mov_b32 v19, s44
    v_cndmask_b32_e64 v52, v52, v19, s[40:41]
    v_cndmask_b32_e64 v53, v53, v19, s[40:41]
    ds_write_b128 v23, v[52:55] offset:6144
    s_branch L_bar
L_p3:
    s_waitcnt vmcnt(1)
    v_mfma_f32_32x32x16_bf16 v[36:51], v[176:179], v[160:163], 0
    s_waitcnt vmcnt(0)
    v_mfma_f32_32x32x16_bf16 v[36:51], v[180:183], v[164:167], v[36:51]
    s_nop 11
    v_max_f32_e64 v17, |v36|, |v37|
    v_max3_f32 v17, |v38|, |v39|, v17
    v_max3_f32 v17, |v40|, |v41|, v17
    v_max3_f32 v17, |v42|, |v43|, v17
    v_max3_f32 v17, |v44|, |v45|, v17
    v_max3_f32 v17, |v46|, |v47|, v17
    v_max3_f32 v17, |v48|, |v49|, v17
    v_max3_f32 v17, |v50|, |v51|, v17
    s_nop 0
    v_readlane_b32 s42, v17, 0
    v_readlane_b32 s43, v17, 32
    s_nop 1
    s_max_u32 s42, s42, s43
    s_lshr_b32 s42, s42, 23
    s_sub_i32 s42, 141, s42
    s_min_i32 s42, s42, 40
    v_mov_b32 v20, s42
    v_ldexp_f32 v18, 1.0, s42
    ds_write_b32 v15, v20 offset:140
    v_cndmask_b32_e64 v18, 0, v18, s[52:53]
    v_pk_mul_f32 v[36:37], v[36:37], v[18:19] op_sel:[0,0] op_sel_hi:[1,0]
    v_pk_mul_f32 v[38:39], v[38:39], v[18:19] op_sel:[0,0] op_sel_hi:[1,0]
    v_pk_mul_f32 v[40:41], v[40:41], v[18:19] op_sel:[0,0] op_sel_hi:[1,0]
    v_pk_mul_f32 v[42:43], v[42:43], v[18:19] op_sel:[0,0] op_sel_hi:[1,0]
    v_pk_mul_f32 v[44:45], v[44:45], v[18:19] op_sel:[0,0] op_sel_hi:[1,0]
    v_pk_mul_f32 v[46:47], v[46:47], v[18:19] op_sel:[0,0] op_sel_hi:[1,0]
    v_pk_mul_f32 v[48:49], v[48:49], v[18:19] op_sel:[0,0] op_sel_hi:[1,0]
    v_pk_mul_f32 v[50:51], v[50:51], v[18:19] op_sel:[0,0] op_sel_hi:[1,0]
    v_pk_mul_f32 v[20:21], v[36:37], v[36:37]
    v_pk_fma_f32 v[20:21], v[38:39], v[38:39], v[20:21]
    v_pk_fma_f32 v[20:21], v[40:41], v[40:41], v[20:21]
    v_pk_fma_f32 v[20:21], v[42:43], v[42:43], v[20:21]
    v_pk_fma_f32 v[20:21], v[44:45], v[44:45], v[20:21]
    v_pk_fma_f32 v[20:21], v[46:47], v[46:47], v[20:21]
    v_pk_fma_f32 v[20:21], v[48:49], v[48:49], v[20:21]
    v_pk_fma_f32 v[20:21], v[50:51], v[50:51], v[20:21]
    v_add_f32 v20, v20, v21
    v_cvt_pk_f16_f32 v36, v36, v37
    v_readlane_b32 s42, v20, 0
    v_readlane_b32 s43, v20, 32
    v_cvt_pk_f16_f32 v37, v38, v39
    v_cvt_pk_f16_f32 v38, v40, v41
    v_mov_b32 v20, s42
    v_add_f32 v20, s43, v20
    v_sqrt_f32 v20, v20
    v_cvt_pk_f16_f32 v39, v42, v43
    v_cvt_pk_f16_f32 v40, v44, v45
    v_cvt_pk_f16_f32 v41, v46, v47
    v_cvt_pk_f16_f32 v42, v48, v49
    v_cvt_pk_f16_f32 v43, v50, v51
    v_max_f32 v20, 0x46800000, v20
    v_mul_f32 v20, 0x33000000, v20
    ds_write_b32 v15, v20 offset:132
    s_mov_b32 exec_lo, 0xaaaaaaaa
    s_mov_b32 exec_hi, exec_lo
    ds_write_b128 v23, v[36:39] offset:2048
    ds_write_b128 v23, v[40:43] offset:3072
    s_mov_b64 exec, -1
L_bar:
    s_waitcnt lgkmcnt(0)
    s_setprio 3
    s_barrier
    s_cmp_ge_u32 s28, 4
    s_cbranch_scc1 L_b3
    ds_read_b64 v[116:117], v23 offset:5120
    ds_read_b128 v[16:19], v15 offset:128
    ds_read_b32 v20, v15 offset:144
    ds_read_b128 v[68:71], v15 offset:0
    ds_read_b128 v[72:75], v15 offset:16
    ds_read_b128 v[76:79], v15 offset:64
    ds_read_b128 v[80:83], v15 offset:80
    ds_read_b128 v[108:111], v23 offset:4096
    ds_read_b128 v[112:115], v22 offset:4096
    ds_read_b128 v[28:31], v23 offset:6144
    ds_read_b128 v[84:87], v23 offset:0
    ds_read_b128 v[88:91], v23 offset:1024
    ds_read_b128 v[92:95], v23 offset:2048
    ds_read_b128 v[96:99], v23 offset:3072
    ds_read_b128 v[100:103], v22 offset:2048
    ds_read_b128 v[104:107], v22 offset:3072
    s_waitcnt lgkmcnt(13)
    v_lshl_add_u32 v20, v18, 1, v20
    v_add_u32 v21, 28, v20
    v_ashrrev_i32 v21, 31, v21
    v_or_b32 v118, v16, v21
    v_rcp_f32 v16, v17
    v_readfirstlane_b32 s31, v17
    v_lshl_add_u32 v15, v18, 1, v19
    v_readfirstlane_b32 s30, v16
    v_sub_u32 v15, 0, v15
    s_add_u32 s31, s31, 67108864
    v_sub_u32 v16, 383, v20
    v_ldexp_f32 v20, 1.0, v20
    v_mul_u32_u24 v16, 0x800080, v16
    s_waitcnt lgkmcnt(9)
    v_pk_mul_f32 v[68:69], v[68:69], v[20:21] op_sel:[0,0] op_sel_hi:[1,0]
    v_pk_mul_f32 v[70:71], v[70:71], v[20:21] op_sel:[0,0] op_sel_hi:[1,0]
    v_pk_mul_f32 v[72:73], v[72:73], v[20:21] op_sel:[0,0] op_sel_hi:[1,0]
    v_pk_mul_f32 v[74:75], v[74:75], v[20:21] op_sel:[0,0] op_sel_hi:[1,0]
    v_pk_mul_f32 v[76:77], v[76:77], v[20:21] op_sel:[0,0] op_sel_hi:[1,0]
    v_pk_mul_f32 v[78:79], v[78:79], v[20:21] op_sel:[0,0] op_sel_hi:[1,0]
    v_pk_mul_f32 v[80:81], v[80:81], v[20:21] op_sel:[0,0] op_sel_hi:[1,0]
    v_pk_mul_f32 v[82:83], v[82:83], v[20:21] op_sel:[0,0] op_sel_hi:[1,0]
    s_waitcnt lgkmcnt(6)
    v_and_b32 v108, v16, v108
    v_and_b32 v109, v16, v109
    v_and_b32 v110, v16, v110
    v_and_b32 v111, v16, v111
    v_and_b32 v112, v16, v112
    v_and_b32 v113, v16, v113
    v_and_b32 v114, v16, v114
    v_and_b32 v115, v16, v115
    v_and_b32 v28, v16, v28
    v_and_b32 v29, v16, v29
    v_and_b32 v30, v16, v30
    v_and_b32 v31, v16, v31
    s_branch L_a3
L_b3:
    global_load_dwordx2 v[32:33], v14, s[4:5] nt
    ds_read_b64 v[116:117], v23 offset:5120
    ds_read_b128 v[16:19], v15 offset:128
    ds_read_b32 v20, v15 offset:144
    ds_read_b128 v[68:71], v15 offset:0
    ds_read_b128 v[72:75], v15 offset:16
    ds_read_b128 v[76:79], v15 offset:64
    ds_read_b128 v[80:83], v15 offset:80
    ds_read_b128 v[108:111], v23 offset:4096
    ds_read_b128 v[112:115], v22 offset:4096
    ds_read_b128 v[28:31], v23 offset:6144
    ds_read_b128 v[84:87], v23 offset:0
    ds_read_b128 v[88:91], v23 offset:1024
    ds_read_b128 v[92:95], v23 offset:2048
    ds_read_b128 v[96:99], v23 offset:3072
    ds_read_b128 v[100:103], v22 offset:2048
    ds_read_b128 v[104:107], v22 offset:3072
    s_waitcnt lgkmcnt(13)
    v_lshl_add_u32 v20, v18, 1, v20
    v_add_u32 v21, 28, v20
    v_ashrrev_i32 v21, 31, v21
    v_or_b32 v118, v16, v21
    v_rcp_f32 v16, v17
    v_readfirstlane_b32 s31, v17
    v_lshl_add_u32 v15, v18, 1, v19
    v_readfirstlane_b32 s30, v16
    v_sub_u32 v15, 0, v15
    s_add_u32 s31, s31, 67108864
    v_sub_u32 v16, 383, v20
    v_ldexp_f32 v20, 1.0, v20
    v_mul_u32_u24 v16, 0x800080, v16
    s_waitcnt lgkmcnt(9)
    v_pk_mul_f32 v[68:69], v[68:69], v[20:21] op_sel:[0,0] op_sel_hi:[1,0]
    v_pk_mul_f32 v[70:71], v[70:71], v[20:21] op_sel:[0,0] op_sel_hi:[1,0]
    v_pk_mul_f32 v[72:73], v[72:73], v[20:21] op_sel:[0,0] op_sel_hi:[1,0]
    v_pk_mul_f32 v[74:75], v[74:75], v[20:21] op_sel:[0,0] op_sel_hi:[1,0]
    v_pk_mul_f32 v[76:77], v[76:77], v[20:21] op_sel:[0,0] op_sel_hi:[1,0]
    v_pk_mul_f32 v[78:79], v[78:79], v[20:21] op_sel:[0,0] op_sel_hi:[1,0]
    v_pk_mul_f32 v[80:81], v[80:81], v[20:21] op_sel:[0,0] op_sel_hi:[1,0]
    v_pk_mul_f32 v[82:83], v[82:83], v[20:21] op_sel:[0,0] op_sel_hi:[1,0]
    s_waitcnt lgkmcnt(6)
    v_and_b32 v108, v16, v108
    v_and_b32 v109, v16, v109
    v_and_b32 v110, v16, v110
    v_and_b32 v111, v16, v111
    v_and_b32 v112, v16, v112
    v_and_b32 v113, v16, v113
    v_and_b32 v114, v16, v114
    v_and_b32 v115, v16, v115
    v_and_b32 v28, v16, v28
    v_and_b32 v29, v16, v29
    v_and_b32 v30, v16, v30
    v_and_b32 v31, v16, v31
    s_waitcnt vmcnt(0)
    v_lshlrev_b32 v32, 6, v32
    v_lshlrev_b32 v33, 6, v33
    s_nop 0
    v_add_u32_dpp v11, v32, v10 quad_perm:[0,0,0,0] row_mask:0xf bank_mask:0xf
    buffer_load_dwordx4 v[144:147], v11, s[20:23], 0 offen
    s_nop 0
    v_add_u32_dpp v11, v33, v10 quad_perm:[0,0,0,0] row_mask:0xf bank_mask:0xf
    buffer_load_dwordx4 v[148:151], v11, s[20:23], 0 offen
    s_nop 0
    v_add_u32_dpp v11, v32, v10 quad_perm:[1,1,1,1] row_mask:0xf bank_mask:0xf
    buffer_load_dwordx4 v[152:155], v11, s[20:23], 0 offen
    s_nop 0
L_a3:
    v_add_u32 v14, v26, v14
    v_add_u32_dpp v11, v33, v10 quad_perm:[1,1,1,1] row_mask:0xf bank_mask:0xf
    buffer_load_dwordx4 v[156:159], v11, s[20:23], 0 offen
L_start:
    s_waitcnt vmcnt(3)
    v_mfma_f32_4x4x4_16b_bf16 v[36:39], v[116:117], v[144:145], 0
    v_mfma_f32_4x4x4_16b_bf16 v[40:43], v[116:117], v[146:147], 0
    s_waitcnt vmcnt(2)
    v_mfma_f32_4x4x4_16b_bf16 v[44:47], v[116:117], v[148:149], 0
    v_mfma_f32_4x4x4_16b_bf16 v[48:51], v[116:117], v[150:151], 0
    s_nop 0
    v_cvt_pk_f16_f32 v36, v36, v37
    v_cvt_pk_f16_f32 v37, v38, v39
    v_cvt_pk_f16_f32 v38, v40, v41
    v_cvt_pk_f16_f32 v39, v42, v43
    ds_write_b128 v9, v[36:39] offset:0
    v_cvt_pk_f16_f32 v44, v44, v45
    v_cvt_pk_f16_f32 v45, v46, v47
    v_cvt_pk_f16_f32 v46, v48, v49
    v_cvt_pk_f16_f32 v47, v50, v51
    ds_write_b128 v9, v[44:47] offset:1088
    ds_read_b128 v[160:163], v1 offset:0
    ds_read_b128 v[164:167], v1 offset:32
    ds_read_b128 v[168:171], v2 offset:0
    ds_read_b128 v[172:175], v2 offset:32
    ds_read_b128 v[176:179], v3 offset:0
    ds_read_b128 v[180:183], v3 offset:32
    s_waitcnt lgkmcnt(3)
    v_pk_mul_f16 v24, v160, v168
    v_pk_mul_f16 v25, v161, v169
    v_pk_mul_f16 v26, v162, v170
    v_pk_mul_f16 v27, v163, v171
    s_waitcnt lgkmcnt(0)
    s_setprio 2
.p2align 3
    v_mfma_f32_16x16x32_f16 v[128:131], v[92:95], v[24:27], 0
    v_mfma_f32_32x32x16_f16 v[36:51], v[84:87], v[24:27], v[68:83]
    v_pk_mul_f16 v20, v164, v172
    v_pk_mul_f16 v21, v165, v173
    v_pk_mul_f16 v22, v166, v174
    v_pk_mul_f16 v23, v167, v175
    s_nop 0
    s_nop 0
    v_mfma_f32_32x32x16_f16 v[36:51], v[88:91], v[20:23], v[36:51]
    v_pk_mul_f16 v24, v168, v176
    v_pk_mul_f16 v25, v169, v177
    v_mfma_f32_16x16x32_f16 v[128:131], v[96:99], v[20:23], v[128:131]
    v_pk_mul_f16 v26, v170, v178
    v_pk_mul_f16 v27, v171, v179
    s_nop 4
    s_nop 0
    v_mfma_f32_16x16x32_f16 v[128:131], v[100:103], v[24:27], v[128:131]
    v_pk_mul_f16 v20, v172, v180
    v_pk_mul_f16 v21, v173, v181
    v_mfma_f32_32x32x16_f16 v[52:67], v[84:87], v[24:27], v[68:83]
    v_pk_mul_f16 v22, v174, v182
    v_pk_mul_f16 v23, v175, v183
    v_add_f32_e64 v36, |v36|, |v44|
    v_add_f32_e64 v37, |v37|, |v45|
    v_add_f32_e64 v38, |v38|, |v46|
    v_add_f32_e64 v39, |v39|, |v47|
    v_mfma_f32_32x32x16_f16 v[52:67], v[88:91], v[20:23], v[52:67]
    v_add_f32_e64 v40, |v40|, |v48|
    v_add_f32_e64 v41, |v41|, |v49|
    v_add_f32_e64 v42, |v42|, |v50|
    v_fma_f32 v43, |v43|, v118, |v51|
    v_pk_mul_f16 v24, v160, v176
    v_pk_mul_f16 v25, v161, v177
    v_mfma_f32_16x16x32_f16 v[128:131], v[104:107], v[20:23], v[128:131]
    s_waitcnt vmcnt(1)
    s_nop 0
    v_pk_mul_f16 v26, v162, v178
    v_pk_mul_f16 v27, v163, v179
    v_mfma_f32_4x4x4_16b_bf16 v[120:123], v[116:117], v[152:153], 0
    v_mfma_f32_4x4x4_16b_bf16 v[124:127], v[116:117], v[154:155], 0
    v_smfmac_f32_16x16x64_bf16 v[128:131], v[108:111], v[36:43], v12
    ds_read_b128 v[184:187], v5 offset:0
    v_add_u32_dpp v11, v32, v10 quad_perm:[2,2,2,2] row_mask:0xf bank_mask:0xf
    s_nop 1
    s_nop 0
    v_cvt_pk_f16_f32 v120, v120, v121
    v_cvt_pk_f16_f32 v121, v122, v123
    v_cvt_pk_f16_f32 v122, v124, v125
    v_cvt_pk_f16_f32 v123, v126, v127
    v_mfma_f32_16x16x32_f16 v[132:135], v[92:95], v[24:27], 0
    ds_write_b128 v9, v[120:123] offset:2176
    v_pk_mul_f16 v20, v164, v180
    v_pk_mul_f16 v21, v165, v181
    v_mfma_f32_32x32x16_f16 v[36:51], v[84:87], v[24:27], v[68:83]
    ds_read_b128 v[192:195], v4 offset:2176
    ds_read_b128 v[196:199], v4 offset:2208
    v_pk_mul_f16 v22, v166, v182
    v_pk_mul_f16 v23, v167, v183
    v_add_f32_e64 v52, |v52|, |v60|
    v_add_f32_e64 v53, |v53|, |v61|
    v_add_f32_e64 v54, |v54|, |v62|
    v_add_f32_e64 v55, |v55|, |v63|
    v_mfma_f32_32x32x16_f16 v[36:51], v[88:91], v[20:23], v[36:51]
    s_waitcnt lgkmcnt(0)
    s_nop 0
    v_add_f32_e64 v56, |v56|, |v64|
    v_add_f32_e64 v57, |v57|, |v65|
    v_add_f32_e64 v58, |v58|, |v66|
    v_fma_f32 v59, |v59|, v118, |v67|
    v_pk_mul_f16 v24, v192, v160
    v_pk_mul_f16 v25, v193, v161
    v_mfma_f32_16x16x32_f16 v[132:135], v[96:99], v[20:23], v[132:135]
    v_pk_mul_f16 v26, v194, v162
    v_pk_mul_f16 v27, v195, v163
    v_smfmac_f32_16x16x64_bf16 v[128:131], v[112:115], v[52:59], v12
    buffer_load_dwordx4 v[144:147], v11, s[20:23], 0 offen
    v_mfma_f32_16x16x32_f16 v[132:135], v[100:103], v[24:27], v[132:135]
    ds_read_b128 v[188:191], v5 offset:32
    v_pk_mul_f16 v20, v196, v164
    v_pk_mul_f16 v21, v197, v165
    v_mfma_f32_32x32x16_f16 v[52:67], v[84:87], v[24:27], v[68:83]
    v_pk_mul_f16 v22, v198, v166
    v_pk_mul_f16 v23, v199, v167
    v_add_f32_e64 v36, |v36|, |v44|
    v_add_f32_e64 v37, |v37|, |v45|
    v_add_f32_e64 v38, |v38|, |v46|
    v_add_f32_e64 v39, |v39|, |v47|
    v_mfma_f32_32x32x16_f16 v[52:67], v[88:91], v[20:23], v[52:67]
    v_add_f32_e64 v40, |v40|, |v48|
    v_add_f32_e64 v41, |v41|, |v49|
    v_add_f32_e64 v42, |v42|, |v50|
    v_fma_f32 v43, |v43|, v118, |v51|
    v_pk_mul_f16 v24, v192, v168
    v_pk_mul_f16 v25, v193, v169
    v_mfma_f32_16x16x32_f16 v[132:135], v[104:107], v[20:23], v[132:135]
    v_pk_mul_f16 v26, v194, v170
    v_pk_mul_f16 v27, v195, v171
    v_smfmac_f32_16x16x64_bf16 v[132:135], v[108:111], v[36:43], v12
    global_load_dwordx2 v[34:35], v14, s[4:5] nt
    v_exp_f32_e64 v16, v128
    v_cmp_le_f32_e64 s[32:33], s31, |v129|
    v_mul_f32_e64 v17, v16, v129
    v_mfma_f32_16x16x32_f16 v[136:139], v[92:95], v[24:27], 0
    v_pk_mul_f16 v20, v196, v172
    v_pk_mul_f16 v21, v197, v173
    v_mfma_f32_32x32x16_f16 v[36:51], v[84:87], v[24:27], v[68:83]
    v_pk_mul_f16 v22, v198, v174
    v_pk_mul_f16 v23, v199, v175
    v_add_f32_e64 v52, |v52|, |v60|
    v_add_f32_e64 v53, |v53|, |v61|
    v_add_f32_e64 v54, |v54|, |v62|
    v_add_f32_e64 v55, |v55|, |v63|
    v_mfma_f32_32x32x16_f16 v[36:51], v[88:91], v[20:23], v[36:51]
    v_add_f32_e64 v56, |v56|, |v64|
    v_add_f32_e64 v57, |v57|, |v65|
    v_add_f32_e64 v58, |v58|, |v66|
    v_fma_f32 v59, |v59|, v118, |v67|
    v_pk_mul_f16 v24, v192, v176
    v_pk_mul_f16 v25, v193, v177
    v_mfma_f32_16x16x32_f16 v[136:139], v[96:99], v[20:23], v[136:139]
    v_pk_mul_f16 v26, v194, v178
    v_pk_mul_f16 v27, v195, v179
    v_smfmac_f32_16x16x64_bf16 v[132:135], v[112:115], v[52:59], v12
    ds_read_b128 v[200:203], v7 offset:0
    s_waitcnt lgkmcnt(1)
    s_nop 0
    v_mfma_f32_16x16x32_f16 v[136:139], v[100:103], v[24:27], v[136:139]
    v_pk_mul_f16 v20, v196, v180
    v_pk_mul_f16 v21, v197, v181
    v_mfma_f32_32x32x16_f16 v[52:67], v[84:87], v[24:27], v[68:83]
    v_pk_mul_f16 v22, v198, v182
    v_pk_mul_f16 v23, v199, v183
    v_add_f32_e64 v36, |v36|, |v44|
    v_add_f32_e64 v37, |v37|, |v45|
    v_add_f32_e64 v38, |v38|, |v46|
    v_add_f32_e64 v39, |v39|, |v47|
    v_mfma_f32_32x32x16_f16 v[52:67], v[88:91], v[20:23], v[52:67]
    v_add_f32_e64 v40, |v40|, |v48|
    v_add_f32_e64 v41, |v41|, |v49|
    v_add_f32_e64 v42, |v42|, |v50|
    v_fma_f32 v43, |v43|, v118, |v51|
    v_pk_mul_f16 v24, v192, v184
    v_pk_mul_f16 v25, v193, v185
    v_mfma_f32_16x16x32_f16 v[136:139], v[104:107], v[20:23], v[136:139]
    s_waitcnt vmcnt(2)
    s_nop 0
    v_pk_mul_f16 v26, v194, v186
    v_pk_mul_f16 v27, v195, v187
    v_mfma_f32_4x4x4_16b_bf16 v[120:123], v[116:117], v[156:157], 0
    v_exp_f32_e64 v132, v132
    v_mfma_f32_4x4x4_16b_bf16 v[124:127], v[116:117], v[158:159], 0
    v_add_f32_e64 v16, v16, v132
    v_smfmac_f32_16x16x64_bf16 v[136:139], v[108:111], v[36:43], v12
    ds_read_b128 v[204:207], v7 offset:32
    v_cvt_pk_f16_f32 v120, v120, v121
    v_cvt_pk_f16_f32 v121, v122, v123
    v_cvt_pk_f16_f32 v122, v124, v125
    v_cvt_pk_f16_f32 v123, v126, v127
    v_mfma_f32_16x16x32_f16 v[140:143], v[92:95], v[24:27], 0
    ds_write_b128 v9, v[120:123] offset:3264
    v_pk_mul_f16 v20, v196, v188
    v_pk_mul_f16 v21, v197, v189
    v_mfma_f32_32x32x16_f16 v[36:51], v[84:87], v[24:27], v[68:83]
    ds_read_b128 v[208:211], v4 offset:3264
    ds_read_b128 v[212:215], v4 offset:3296
    v_pk_mul_f16 v22, v198, v190
    v_pk_mul_f16 v23, v199, v191
    v_add_f32_e64 v52, |v52|, |v60|
    v_add_f32_e64 v53, |v53|, |v61|
    v_add_f32_e64 v54, |v54|, |v62|
    v_add_f32_e64 v55, |v55|, |v63|
    v_mfma_f32_32x32x16_f16 v[36:51], v[88:91], v[20:23], v[36:51]
    s_waitcnt lgkmcnt(0)
    s_nop 0
    v_add_f32_e64 v56, |v56|, |v64|
    v_add_f32_e64 v57, |v57|, |v65|
    v_add_f32_e64 v58, |v58|, |v66|
    v_fma_f32 v59, |v59|, v118, |v67|
    v_pk_mul_f16 v24, v208, v160
    v_pk_mul_f16 v25, v209, v161
    v_mfma_f32_16x16x32_f16 v[140:143], v[96:99], v[20:23], v[140:143]
    ds_read_b128 v[216:219], v1 offset:2176
    v_pk_mul_f16 v26, v210, v162
    v_pk_mul_f16 v27, v211, v163
    v_smfmac_f32_16x16x64_bf16 v[136:139], v[112:115], v[52:59], v12
    ds_read_b128 v[220:223], v1 offset:2208
    v_fmac_f32_e64 v17, v132, v133
    v_mfma_f32_16x16x32_f16 v[140:143], v[100:103], v[24:27], v[140:143]
    ds_read_b128 v[224:227], v2 offset:2176
    v_pk_mul_f16 v20, v212, v164
    v_pk_mul_f16 v21, v213, v165
    v_mfma_f32_32x32x16_f16 v[52:67], v[84:87], v[24:27], v[68:83]
    v_pk_mul_f16 v22, v214, v166
    v_pk_mul_f16 v23, v215, v167
    v_add_f32_e64 v36, |v36|, |v44|
    v_add_f32_e64 v37, |v37|, |v45|
    v_add_f32_e64 v38, |v38|, |v46|
    v_add_f32_e64 v39, |v39|, |v47|
    v_mfma_f32_32x32x16_f16 v[52:67], v[88:91], v[20:23], v[52:67]
    v_add_f32_e64 v40, |v40|, |v48|
    v_add_f32_e64 v41, |v41|, |v49|
    v_add_f32_e64 v42, |v42|, |v50|
    v_fma_f32 v43, |v43|, v118, |v51|
    v_pk_mul_f16 v24, v208, v168
    v_pk_mul_f16 v25, v209, v169
    v_mfma_f32_16x16x32_f16 v[140:143], v[104:107], v[20:23], v[140:143]
    v_pk_mul_f16 v26, v210, v170
    v_pk_mul_f16 v27, v211, v171
    v_smfmac_f32_16x16x64_bf16 v[140:143], v[108:111], v[36:43], v12
    ds_read_b128 v[228:231], v2 offset:2208
    v_exp_f32_e64 v136, v136
    v_mfma_f32_16x16x32_f16 v[128:131], v[92:95], v[24:27], 0
    v_pk_mul_f16 v20, v212, v172
    v_pk_mul_f16 v21, v213, v173
    v_mfma_f32_32x32x16_f16 v[36:51], v[84:87], v[24:27], v[68:83]
    v_pk_mul_f16 v22, v214, v174
    v_pk_mul_f16 v23, v215, v175
    v_add_f32_e64 v52, |v52|, |v60|
    v_add_f32_e64 v53, |v53|, |v61|
    v_add_f32_e64 v54, |v54|, |v62|
    v_add_f32_e64 v55, |v55|, |v63|
    v_mfma_f32_32x32x16_f16 v[36:51], v[88:91], v[20:23], v[36:51]
    v_add_f32_e64 v56, |v56|, |v64|
    v_add_f32_e64 v57, |v57|, |v65|
    v_add_f32_e64 v58, |v58|, |v66|
    v_fma_f32 v59, |v59|, v118, |v67|
    v_pk_mul_f16 v24, v208, v176
    v_pk_mul_f16 v25, v209, v177
    v_mfma_f32_16x16x32_f16 v[128:131], v[96:99], v[20:23], v[128:131]
    v_pk_mul_f16 v26, v210, v178
    v_pk_mul_f16 v27, v211, v179
    v_smfmac_f32_16x16x64_bf16 v[140:143], v[112:115], v[52:59], v12
    ds_read_b128 v[232:235], v3 offset:2176
    v_add_f32_e64 v16, v16, v136
    v_fmac_f32_e64 v17, v136, v137
    v_add_u32_dpp v11, v33, v10 quad_perm:[2,2,2,2] row_mask:0xf bank_mask:0xf
    v_mfma_f32_16x16x32_f16 v[128:131], v[100:103], v[24:27], v[128:131]
    v_pk_mul_f16 v20, v212, v180
    v_pk_mul_f16 v21, v213, v181
    v_mfma_f32_32x32x16_f16 v[52:67], v[84:87], v[24:27], v[68:83]
    v_pk_mul_f16 v22, v214, v182
    v_pk_mul_f16 v23, v215, v183
    v_add_f32_e64 v36, |v36|, |v44|
    v_add_f32_e64 v37, |v37|, |v45|
    v_add_f32_e64 v38, |v38|, |v46|
    v_add_f32_e64 v39, |v39|, |v47|
    v_mfma_f32_32x32x16_f16 v[52:67], v[88:91], v[20:23], v[52:67]
    v_add_f32_e64 v40, |v40|, |v48|
    v_add_f32_e64 v41, |v41|, |v49|
    v_add_f32_e64 v42, |v42|, |v50|
    v_fma_f32 v43, |v43|, v118, |v51|
    v_pk_mul_f16 v24, v208, v184
    v_pk_mul_f16 v25, v209, v185
    v_mfma_f32_16x16x32_f16 v[128:131], v[104:107], v[20:23], v[128:131]
    v_pk_mul_f16 v26, v210, v186
    v_pk_mul_f16 v27, v211, v187
    v_smfmac_f32_16x16x64_bf16 v[128:131], v[108:111], v[36:43], v12
    buffer_load_dwordx4 v[148:151], v11, s[20:23], 0 offen
    s_waitcnt lgkmcnt(1)
    v_exp_f32_e32 v140, v140
    v_mfma_f32_16x16x32_f16 v[132:135], v[92:95], v[24:27], 0
    ds_read_b128 v[236:239], v3 offset:2208
    v_pk_mul_f16 v20, v212, v188
    v_pk_mul_f16 v21, v213, v189
    v_mfma_f32_32x32x16_f16 v[36:51], v[84:87], v[24:27], v[68:83]
    v_pk_mul_f16 v22, v214, v190
    v_pk_mul_f16 v23, v215, v191
    v_add_f32_e64 v52, |v52|, |v60|
    v_add_f32_e64 v53, |v53|, |v61|
    v_add_f32_e64 v54, |v54|, |v62|
    v_add_f32_e64 v55, |v55|, |v63|
    v_mfma_f32_32x32x16_f16 v[36:51], v[88:91], v[20:23], v[36:51]
    v_add_f32_e64 v56, |v56|, |v64|
    v_add_f32_e64 v57, |v57|, |v65|
    v_add_f32_e64 v58, |v58|, |v66|
    v_fma_f32 v59, |v59|, v118, |v67|
    v_pk_mul_f16 v24, v216, v224
    v_pk_mul_f16 v25, v217, v225
    v_mfma_f32_16x16x32_f16 v[132:135], v[96:99], v[20:23], v[132:135]
    v_pk_mul_f16 v26, v218, v226
    v_pk_mul_f16 v27, v219, v227
    v_smfmac_f32_16x16x64_bf16 v[128:131], v[112:115], v[52:59], v12
    ds_read_b128 v[240:243], v7 offset:1088
    s_waitcnt lgkmcnt(1)
    v_add_f32_e32 v16, v16, v140
    v_fmac_f32_e64 v17, v140, v141
    v_mfma_f32_16x16x32_f16 v[132:135], v[100:103], v[24:27], v[132:135]
    v_pk_mul_f16 v20, v220, v228
    v_pk_mul_f16 v21, v221, v229
    v_mfma_f32_32x32x16_f16 v[52:67], v[84:87], v[24:27], v[68:83]
    v_pk_mul_f16 v22, v222, v230
    v_pk_mul_f16 v23, v223, v231
    v_add_f32_e64 v36, |v36|, |v44|
    v_add_f32_e64 v37, |v37|, |v45|
    v_add_f32_e64 v38, |v38|, |v46|
    v_add_f32_e64 v39, |v39|, |v47|
    v_mfma_f32_32x32x16_f16 v[52:67], v[88:91], v[20:23], v[52:67]
    v_add_f32_e64 v40, |v40|, |v48|
    v_add_f32_e64 v41, |v41|, |v49|
    v_add_f32_e64 v42, |v42|, |v50|
    v_fma_f32 v43, |v43|, v118, |v51|
    v_pk_mul_f16 v24, v224, v232
    v_pk_mul_f16 v25, v225, v233
    v_mfma_f32_16x16x32_f16 v[132:135], v[104:107], v[20:23], v[132:135]
    v_pk_mul_f16 v26, v226, v234
    v_pk_mul_f16 v27, v227, v235
    v_smfmac_f32_16x16x64_bf16 v[132:135], v[108:111], v[36:43], v12
    ds_read_b128 v[244:247], v7 offset:1120
    v_exp_f32_e64 v128, v128
    v_mfma_f32_16x16x32_f16 v[136:139], v[92:95], v[24:27], 0
    v_pk_mul_f16 v20, v228, v236
    v_pk_mul_f16 v21, v229, v237
    v_mfma_f32_32x32x16_f16 v[36:51], v[84:87], v[24:27], v[68:83]
    v_pk_mul_f16 v22, v230, v238
    v_pk_mul_f16 v23, v231, v239
    v_add_f32_e64 v52, |v52|, |v60|
    v_add_f32_e64 v53, |v53|, |v61|
    v_add_f32_e64 v54, |v54|, |v62|
    v_add_f32_e64 v55, |v55|, |v63|
    v_mfma_f32_32x32x16_f16 v[36:51], v[88:91], v[20:23], v[36:51]
    v_add_f32_e64 v56, |v56|, |v64|
    v_add_f32_e64 v57, |v57|, |v65|
    v_add_f32_e64 v58, |v58|, |v66|
    v_fma_f32 v59, |v59|, v118, |v67|
    v_pk_mul_f16 v24, v216, v232
    v_pk_mul_f16 v25, v217, v233
    v_mfma_f32_16x16x32_f16 v[136:139], v[96:99], v[20:23], v[136:139]
    s_waitcnt vmcnt(2)
    s_nop 0
    v_pk_mul_f16 v26, v218, v234
    v_pk_mul_f16 v27, v219, v235
    v_mfma_f32_4x4x4_16b_bf16 v[120:123], v[116:117], v[144:145], 0
    v_add_f32_e64 v16, v16, v128
    v_mfma_f32_4x4x4_16b_bf16 v[124:127], v[116:117], v[146:147], 0
    v_fmac_f32_e64 v17, v128, v129
    v_smfmac_f32_16x16x64_bf16 v[132:135], v[112:115], v[52:59], v12
    ds_read_b128 v[248:251], v5 offset:2176
    s_waitcnt lgkmcnt(1)
    s_nop 0
    v_cvt_pk_f16_f32 v120, v120, v121
    v_cvt_pk_f16_f32 v121, v122, v123
    v_cvt_pk_f16_f32 v122, v124, v125
    v_cvt_pk_f16_f32 v123, v126, v127
    v_mfma_f32_16x16x32_f16 v[136:139], v[100:103], v[24:27], v[136:139]
    ds_write_b128 v9, v[120:123] offset:4352
    v_pk_mul_f16 v20, v220, v236
    v_pk_mul_f16 v21, v221, v237
    v_mfma_f32_32x32x16_f16 v[52:67], v[84:87], v[24:27], v[68:83]
    ds_read_b128 v[192:195], v4 offset:4352
    v_pk_mul_f16 v22, v222, v238
    v_pk_mul_f16 v23, v223, v239
    v_add_f32_e64 v36, |v36|, |v44|
    v_add_f32_e64 v37, |v37|, |v45|
    v_add_f32_e64 v38, |v38|, |v46|
    v_add_f32_e64 v39, |v39|, |v47|
    v_mfma_f32_32x32x16_f16 v[52:67], v[88:91], v[20:23], v[52:67]
    ds_read_b128 v[196:199], v4 offset:4384
    v_add_f32_e64 v40, |v40|, |v48|
    v_add_f32_e64 v41, |v41|, |v49|
    v_add_f32_e64 v42, |v42|, |v50|
    v_fma_f32 v43, |v43|, v118, |v51|
    v_pk_mul_f16 v24, v200, v240
    v_pk_mul_f16 v25, v201, v241
    v_mfma_f32_16x16x32_f16 v[136:139], v[104:107], v[20:23], v[136:139]
    v_pk_mul_f16 v26, v202, v242
    v_pk_mul_f16 v27, v203, v243
    v_smfmac_f32_16x16x64_bf16 v[136:139], v[108:111], v[36:43], v12
    ds_read_b128 v[252:255], v5 offset:2208
    v_exp_f32_e64 v132, v132
    v_mfma_f32_16x16x32_f16 v[140:143], v[92:95], v[24:27], 0
    v_pk_mul_f16 v20, v204, v244
    v_pk_mul_f16 v21, v205, v245
    v_mfma_f32_32x32x16_f16 v[36:51], v[84:87], v[24:27], v[68:83]
    v_pk_mul_f16 v22, v206, v246
    v_pk_mul_f16 v23, v207, v247
    v_add_f32_e64 v52, |v52|, |v60|
    v_add_f32_e64 v53, |v53|, |v61|
    v_add_f32_e64 v54, |v54|, |v62|
    v_add_f32_e64 v55, |v55|, |v63|
    v_mfma_f32_32x32x16_f16 v[36:51], v[88:91], v[20:23], v[36:51]
    s_waitcnt lgkmcnt(1)
    s_nop 0
    v_add_f32_e64 v56, |v56|, |v64|
    v_add_f32_e64 v57, |v57|, |v65|
    v_add_f32_e64 v58, |v58|, |v66|
    v_fma_f32 v59, |v59|, v118, |v67|
    v_pk_mul_f16 v24, v192, v160
    v_pk_mul_f16 v25, v193, v161
    v_mfma_f32_16x16x32_f16 v[140:143], v[96:99], v[20:23], v[140:143]
    v_pk_mul_f16 v26, v194, v162
    v_pk_mul_f16 v27, v195, v163
    v_smfmac_f32_16x16x64_bf16 v[136:139], v[112:115], v[52:59], v12
    s_waitcnt vmcnt(1)
    v_add_f32_e32 v16, v16, v132
    v_fmac_f32_e64 v17, v132, v133
    v_lshlrev_b32_e64 v34, 6, v34
    v_lshlrev_b32_e64 v35, 6, v35
    v_mfma_f32_16x16x32_f16 v[140:143], v[100:103], v[24:27], v[140:143]
    v_pk_mul_f16 v20, v196, v164
    v_pk_mul_f16 v21, v197, v165
    v_mfma_f32_32x32x16_f16 v[52:67], v[84:87], v[24:27], v[68:83]
    v_pk_mul_f16 v22, v198, v166
    v_pk_mul_f16 v23, v199, v167
    v_add_f32_e64 v36, |v36|, |v44|
    v_add_f32_e64 v37, |v37|, |v45|
    v_add_f32_e64 v38, |v38|, |v46|
    v_add_f32_e64 v39, |v39|, |v47|
    v_mfma_f32_32x32x16_f16 v[52:67], v[88:91], v[20:23], v[52:67]
    v_add_f32_e64 v40, |v40|, |v48|
    v_add_f32_e64 v41, |v41|, |v49|
    v_add_f32_e64 v42, |v42|, |v50|
    v_fma_f32 v43, |v43|, v118, |v51|
    v_pk_mul_f16 v24, v192, v168
    v_pk_mul_f16 v25, v193, v169
    v_mfma_f32_16x16x32_f16 v[140:143], v[104:107], v[20:23], v[140:143]
    v_pk_mul_f16 v26, v194, v170
    v_pk_mul_f16 v27, v195, v171
    v_smfmac_f32_16x16x64_bf16 v[140:143], v[108:111], v[36:43], v12
    v_exp_f32_e64 v136, v136
    v_add_u32_dpp v11, v35, v10 quad_perm:[3,3,3,3] row_mask:0xf bank_mask:0xf
    v_mfma_f32_16x16x32_f16 v[128:131], v[92:95], v[24:27], 0
    v_pk_mul_f16 v20, v196, v172
    v_pk_mul_f16 v21, v197, v173
    v_mfma_f32_32x32x16_f16 v[36:51], v[84:87], v[24:27], v[68:83]
    v_pk_mul_f16 v22, v198, v174
    v_pk_mul_f16 v23, v199, v175
    v_add_f32_e64 v52, |v52|, |v60|
    v_add_f32_e64 v53, |v53|, |v61|
    v_add_f32_e64 v54, |v54|, |v62|
    v_add_f32_e64 v55, |v55|, |v63|
    v_mfma_f32_32x32x16_f16 v[36:51], v[88:91], v[20:23], v[36:51]
    v_add_f32_e64 v56, |v56|, |v64|
    v_add_f32_e64 v57, |v57|, |v65|
    v_add_f32_e64 v58, |v58|, |v66|
    v_fma_f32 v59, |v59|, v118, |v67|
    v_pk_mul_f16 v24, v192, v176
    v_pk_mul_f16 v25, v193, v177
    v_mfma_f32_16x16x32_f16 v[128:131], v[96:99], v[20:23], v[128:131]
    v_pk_mul_f16 v26, v194, v178
    v_pk_mul_f16 v27, v195, v179
    v_smfmac_f32_16x16x64_bf16 v[140:143], v[112:115], v[52:59], v12
    buffer_load_dwordx4 v[152:155], v11, s[20:23], 0 offen
    v_add_f32_e64 v16, v16, v136
    v_fmac_f32_e64 v17, v136, v137
    v_mfma_f32_16x16x32_f16 v[128:131], v[100:103], v[24:27], v[128:131]
    v_pk_mul_f16 v20, v196, v180
    v_pk_mul_f16 v21, v197, v181
    v_mfma_f32_32x32x16_f16 v[52:67], v[84:87], v[24:27], v[68:83]
    v_pk_mul_f16 v22, v198, v182
    v_pk_mul_f16 v23, v199, v183
    v_add_f32_e64 v36, |v36|, |v44|
    v_add_f32_e64 v37, |v37|, |v45|
    v_add_f32_e64 v38, |v38|, |v46|
    v_add_f32_e64 v39, |v39|, |v47|
    v_mfma_f32_32x32x16_f16 v[52:67], v[88:91], v[20:23], v[52:67]
    v_add_f32_e64 v40, |v40|, |v48|
    v_add_f32_e64 v41, |v41|, |v49|
    v_add_f32_e64 v42, |v42|, |v50|
    v_fma_f32 v43, |v43|, v118, |v51|
    v_pk_mul_f16 v24, v192, v184
    v_pk_mul_f16 v25, v193, v185
    v_mfma_f32_16x16x32_f16 v[128:131], v[104:107], v[20:23], v[128:131]
    v_pk_mul_f16 v26, v194, v186
    v_pk_mul_f16 v27, v195, v187
    v_smfmac_f32_16x16x64_bf16 v[128:131], v[108:111], v[36:43], v12
    v_exp_f32_e64 v140, v140
    v_mfma_f32_16x16x32_f16 v[132:135], v[92:95], v[24:27], 0
    v_pk_mul_f16 v20, v196, v188
    v_pk_mul_f16 v21, v197, v189
    v_mfma_f32_32x32x16_f16 v[36:51], v[84:87], v[24:27], v[68:83]
    v_pk_mul_f16 v22, v198, v190
    v_pk_mul_f16 v23, v199, v191
    v_add_f32_e64 v52, |v52|, |v60|
    v_add_f32_e64 v53, |v53|, |v61|
    v_add_f32_e64 v54, |v54|, |v62|
    v_add_f32_e64 v55, |v55|, |v63|
    v_mfma_f32_32x32x16_f16 v[36:51], v[88:91], v[20:23], v[36:51]
    v_add_f32_e64 v56, |v56|, |v64|
    v_add_f32_e64 v57, |v57|, |v65|
    v_add_f32_e64 v58, |v58|, |v66|
    v_fma_f32 v59, |v59|, v118, |v67|
    v_pk_mul_f16 v24, v192, v216
    v_pk_mul_f16 v25, v193, v217
    v_mfma_f32_16x16x32_f16 v[132:135], v[96:99], v[20:23], v[132:135]
    v_pk_mul_f16 v26, v194, v218
    v_pk_mul_f16 v27, v195, v219
    v_smfmac_f32_16x16x64_bf16 v[128:131], v[112:115], v[52:59], v12
    v_add_f32_e64 v16, v16, v140
    v_fmac_f32_e64 v17, v140, v141
    v_mfma_f32_16x16x32_f16 v[132:135], v[100:103], v[24:27], v[132:135]
    v_pk_mul_f16 v20, v196, v220
    v_pk_mul_f16 v21, v197, v221
    v_mfma_f32_32x32x16_f16 v[52:67], v[84:87], v[24:27], v[68:83]
    v_pk_mul_f16 v22, v198, v222
    v_pk_mul_f16 v23, v199, v223
    v_add_f32_e64 v36, |v36|, |v44|
    v_add_f32_e64 v37, |v37|, |v45|
    v_add_f32_e64 v38, |v38|, |v46|
    v_add_f32_e64 v39, |v39|, |v47|
    v_mfma_f32_32x32x16_f16 v[52:67], v[88:91], v[20:23], v[52:67]
    v_add_f32_e64 v40, |v40|, |v48|
    v_add_f32_e64 v41, |v41|, |v49|
    v_add_f32_e64 v42, |v42|, |v50|
    v_fma_f32 v43, |v43|, v118, |v51|
    v_pk_mul_f16 v24, v192, v224
    v_pk_mul_f16 v25, v193, v225
    v_mfma_f32_16x16x32_f16 v[132:135], v[104:107], v[20:23], v[132:135]
    v_pk_mul_f16 v26, v194, v226
    v_pk_mul_f16 v27, v195, v227
    v_smfmac_f32_16x16x64_bf16 v[132:135], v[108:111], v[36:43], v12
    v_exp_f32_e64 v128, v128
    v_mfma_f32_16x16x32_f16 v[136:139], v[92:95], v[24:27], 0
    v_pk_mul_f16 v20, v196, v228
    v_pk_mul_f16 v21, v197, v229
    v_mfma_f32_32x32x16_f16 v[36:51], v[84:87], v[24:27], v[68:83]
    v_pk_mul_f16 v22, v198, v230
    v_pk_mul_f16 v23, v199, v231
    v_add_f32_e64 v52, |v52|, |v60|
    v_add_f32_e64 v53, |v53|, |v61|
    v_add_f32_e64 v54, |v54|, |v62|
    v_add_f32_e64 v55, |v55|, |v63|
    v_mfma_f32_32x32x16_f16 v[36:51], v[88:91], v[20:23], v[36:51]
    v_add_f32_e64 v56, |v56|, |v64|
    v_add_f32_e64 v57, |v57|, |v65|
    v_add_f32_e64 v58, |v58|, |v66|
    v_fma_f32 v59, |v59|, v118, |v67|
    v_pk_mul_f16 v24, v192, v232
    v_pk_mul_f16 v25, v193, v233
    v_mfma_f32_16x16x32_f16 v[136:139], v[96:99], v[20:23], v[136:139]
    s_waitcnt vmcnt(1)
    s_nop 0
    v_pk_mul_f16 v26, v194, v234
    v_pk_mul_f16 v27, v195, v235
    v_mfma_f32_4x4x4_16b_bf16 v[120:123], v[116:117], v[148:149], 0
    v_add_f32_e64 v16, v16, v128
    v_mfma_f32_4x4x4_16b_bf16 v[124:127], v[116:117], v[150:151], 0
    v_fmac_f32_e64 v17, v128, v129
    v_smfmac_f32_16x16x64_bf16 v[132:135], v[112:115], v[52:59], v12
    s_waitcnt lgkmcnt(0)
    s_nop 0
    v_cvt_pk_f16_f32 v120, v120, v121
    v_cvt_pk_f16_f32 v121, v122, v123
    v_cvt_pk_f16_f32 v122, v124, v125
    v_cvt_pk_f16_f32 v123, v126, v127
    v_mfma_f32_16x16x32_f16 v[136:139], v[100:103], v[24:27], v[136:139]
    ds_write_b128 v9, v[120:123] offset:5440
    v_pk_mul_f16 v20, v196, v236
    v_pk_mul_f16 v21, v197, v237
    v_mfma_f32_32x32x16_f16 v[52:67], v[84:87], v[24:27], v[68:83]
    ds_read_b128 v[208:211], v4 offset:5440
    v_pk_mul_f16 v22, v198, v238
    v_pk_mul_f16 v23, v199, v239
    v_add_f32_e64 v36, |v36|, |v44|
    v_add_f32_e64 v37, |v37|, |v45|
    v_add_f32_e64 v38, |v38|, |v46|
    v_add_f32_e64 v39, |v39|, |v47|
    v_mfma_f32_32x32x16_f16 v[52:67], v[88:91], v[20:23], v[52:67]
    ds_read_b128 v[212:215], v4 offset:5472
    v_add_f32_e64 v40, |v40|, |v48|
    v_add_f32_e64 v41, |v41|, |v49|
    v_add_f32_e64 v42, |v42|, |v50|
    v_fma_f32 v43, |v43|, v118, |v51|
    v_pk_mul_f16 v24, v192, v248
    v_pk_mul_f16 v25, v193, v249
    v_mfma_f32_16x16x32_f16 v[136:139], v[104:107], v[20:23], v[136:139]
    v_pk_mul_f16 v26, v194, v250
    v_pk_mul_f16 v27, v195, v251
    v_smfmac_f32_16x16x64_bf16 v[136:139], v[108:111], v[36:43], v12
    ds_read_b128 v[200:203], v1 offset:4352
    v_exp_f32_e64 v132, v132
    v_add_u32_dpp v11, v34, v10 quad_perm:[0,0,0,0] row_mask:0xf bank_mask:0xf
    v_mfma_f32_16x16x32_f16 v[140:143], v[92:95], v[24:27], 0
    v_pk_mul_f16 v20, v196, v252
    v_pk_mul_f16 v21, v197, v253
    v_mfma_f32_32x32x16_f16 v[36:51], v[84:87], v[24:27], v[68:83]
    v_pk_mul_f16 v22, v198, v254
    v_pk_mul_f16 v23, v199, v255
    v_add_f32_e64 v52, |v52|, |v60|
    v_add_f32_e64 v53, |v53|, |v61|
    v_add_f32_e64 v54, |v54|, |v62|
    v_add_f32_e64 v55, |v55|, |v63|
    v_mfma_f32_32x32x16_f16 v[36:51], v[88:91], v[20:23], v[36:51]
    s_waitcnt lgkmcnt(1)
    s_nop 0
    v_add_f32_e64 v56, |v56|, |v64|
    v_add_f32_e64 v57, |v57|, |v65|
    v_add_f32_e64 v58, |v58|, |v66|
    v_fma_f32 v59, |v59|, v118, |v67|
    v_pk_mul_f16 v24, v208, v168
    v_pk_mul_f16 v25, v209, v169
    v_mfma_f32_16x16x32_f16 v[140:143], v[96:99], v[20:23], v[140:143]
    v_pk_mul_f16 v26, v210, v170
    v_pk_mul_f16 v27, v211, v171
    v_smfmac_f32_16x16x64_bf16 v[136:139], v[112:115], v[52:59], v12
    buffer_load_dwordx4 v[156:159], v11, s[20:23], 0 offen
    v_add_f32_e64 v16, v16, v132
    v_fmac_f32_e64 v17, v132, v133
    v_mfma_f32_16x16x32_f16 v[140:143], v[100:103], v[24:27], v[140:143]
    v_pk_mul_f16 v20, v212, v172
    v_pk_mul_f16 v21, v213, v173
    v_mfma_f32_32x32x16_f16 v[52:67], v[84:87], v[24:27], v[68:83]
    v_pk_mul_f16 v22, v214, v174
    v_pk_mul_f16 v23, v215, v175
    v_add_f32_e64 v36, |v36|, |v44|
    v_add_f32_e64 v37, |v37|, |v45|
    v_add_f32_e64 v38, |v38|, |v46|
    v_add_f32_e64 v39, |v39|, |v47|
    v_mfma_f32_32x32x16_f16 v[52:67], v[88:91], v[20:23], v[52:67]
    v_add_f32_e64 v40, |v40|, |v48|
    v_add_f32_e64 v41, |v41|, |v49|
    v_add_f32_e64 v42, |v42|, |v50|
    v_fma_f32 v43, |v43|, v118, |v51|
    v_pk_mul_f16 v24, v208, v184
    v_pk_mul_f16 v25, v209, v185
    v_mfma_f32_16x16x32_f16 v[140:143], v[104:107], v[20:23], v[140:143]
    v_pk_mul_f16 v26, v210, v186
    v_pk_mul_f16 v27, v211, v187
    v_smfmac_f32_16x16x64_bf16 v[140:143], v[108:111], v[36:43], v12
    ds_read_b128 v[204:207], v1 offset:4384
    v_exp_f32_e64 v136, v136
    v_add_u32_dpp v11, v35, v10 quad_perm:[0,0,0,0] row_mask:0xf bank_mask:0xf
    v_mfma_f32_16x16x32_f16 v[128:131], v[92:95], v[24:27], 0
    v_pk_mul_f16 v20, v212, v188
    v_pk_mul_f16 v21, v213, v189
    v_mfma_f32_32x32x16_f16 v[36:51], v[84:87], v[24:27], v[68:83]
    v_pk_mul_f16 v22, v214, v190
    v_pk_mul_f16 v23, v215, v191
    v_add_f32_e64 v52, |v52|, |v60|
    v_add_f32_e64 v53, |v53|, |v61|
    v_add_f32_e64 v54, |v54|, |v62|
    v_add_f32_e64 v55, |v55|, |v63|
    v_mfma_f32_32x32x16_f16 v[36:51], v[88:91], v[20:23], v[36:51]
    v_add_f32_e64 v56, |v56|, |v64|
    v_add_f32_e64 v57, |v57|, |v65|
    v_add_f32_e64 v58, |v58|, |v66|
    v_fma_f32 v59, |v59|, v118, |v67|
    v_pk_mul_f16 v24, v208, v176
    v_pk_mul_f16 v25, v209, v177
    v_mfma_f32_16x16x32_f16 v[128:131], v[96:99], v[20:23], v[128:131]
    v_pk_mul_f16 v26, v210, v178
    v_pk_mul_f16 v27, v211, v179
    v_smfmac_f32_16x16x64_bf16 v[140:143], v[112:115], v[52:59], v12
    buffer_load_dwordx4 v[144:147], v11, s[20:23], 0 offen
    v_add_f32_e64 v16, v16, v136
    v_fmac_f32_e64 v17, v136, v137
    v_mfma_f32_16x16x32_f16 v[128:131], v[100:103], v[24:27], v[128:131]
    ds_read_b128 v[240:243], v2 offset:4352
    v_pk_mul_f16 v20, v212, v180
    v_pk_mul_f16 v21, v213, v181
    v_mfma_f32_32x32x16_f16 v[52:67], v[84:87], v[24:27], v[68:83]
    v_pk_mul_f16 v22, v214, v182
    v_pk_mul_f16 v23, v215, v183
    v_add_f32_e64 v36, |v36|, |v44|
    v_add_f32_e64 v37, |v37|, |v45|
    v_add_f32_e64 v38, |v38|, |v46|
    v_add_f32_e64 v39, |v39|, |v47|
    v_mfma_f32_32x32x16_f16 v[52:67], v[88:91], v[20:23], v[52:67]
    v_add_f32_e64 v40, |v40|, |v48|
    v_add_f32_e64 v41, |v41|, |v49|
    v_add_f32_e64 v42, |v42|, |v50|
    v_fma_f32 v43, |v43|, v118, |v51|
    v_pk_mul_f16 v24, v208, v224
    v_pk_mul_f16 v25, v209, v225
    v_mfma_f32_16x16x32_f16 v[128:131], v[104:107], v[20:23], v[128:131]
    v_pk_mul_f16 v26, v210, v226
    v_pk_mul_f16 v27, v211, v227
    v_smfmac_f32_16x16x64_bf16 v[128:131], v[108:111], v[36:43], v12
    ds_read_b128 v[244:247], v2 offset:4384
    v_exp_f32_e64 v140, v140
    v_mfma_f32_16x16x32_f16 v[132:135], v[92:95], v[24:27], 0
    v_pk_mul_f16 v20, v212, v228
    v_pk_mul_f16 v21, v213, v229
    v_mfma_f32_32x32x16_f16 v[36:51], v[84:87], v[24:27], v[68:83]
    v_pk_mul_f16 v22, v214, v230
    v_pk_mul_f16 v23, v215, v231
    v_add_f32_e64 v52, |v52|, |v60|
    v_add_f32_e64 v53, |v53|, |v61|
    v_add_f32_e64 v54, |v54|, |v62|
    v_add_f32_e64 v55, |v55|, |v63|
    v_mfma_f32_32x32x16_f16 v[36:51], v[88:91], v[20:23], v[36:51]
    v_add_f32_e64 v56, |v56|, |v64|
    v_add_f32_e64 v57, |v57|, |v65|
    v_add_f32_e64 v58, |v58|, |v66|
    v_fma_f32 v59, |v59|, v118, |v67|
    v_pk_mul_f16 v24, v208, v248
    v_pk_mul_f16 v25, v209, v249
    v_mfma_f32_16x16x32_f16 v[132:135], v[96:99], v[20:23], v[132:135]
    v_pk_mul_f16 v26, v210, v250
    v_pk_mul_f16 v27, v211, v251
    v_smfmac_f32_16x16x64_bf16 v[128:131], v[112:115], v[52:59], v12
    ds_read_b128 v[192:195], v3 offset:4352
    v_add_f32_e64 v16, v16, v140
    v_fmac_f32_e64 v17, v140, v141
    v_add_u32_dpp v11, v34, v10 quad_perm:[1,1,1,1] row_mask:0xf bank_mask:0xf
    v_mfma_f32_16x16x32_f16 v[132:135], v[100:103], v[24:27], v[132:135]
    v_pk_mul_f16 v20, v212, v252
    v_pk_mul_f16 v21, v213, v253
    v_mfma_f32_32x32x16_f16 v[52:67], v[84:87], v[24:27], v[68:83]
    v_pk_mul_f16 v22, v214, v254
    v_pk_mul_f16 v23, v215, v255
    v_add_f32_e64 v36, |v36|, |v44|
    v_add_f32_e64 v37, |v37|, |v45|
    v_add_f32_e64 v38, |v38|, |v46|
    v_add_f32_e64 v39, |v39|, |v47|
    v_mfma_f32_32x32x16_f16 v[52:67], v[88:91], v[20:23], v[52:67]
    v_add_f32_e64 v40, |v40|, |v48|
    v_add_f32_e64 v41, |v41|, |v49|
    v_add_f32_e64 v42, |v42|, |v50|
    v_fma_f32 v43, |v43|, v118, |v51|
    v_pk_mul_f16 v24, v208, v232
    v_pk_mul_f16 v25, v209, v233
    v_mfma_f32_16x16x32_f16 v[132:135], v[104:107], v[20:23], v[132:135]
    v_pk_mul_f16 v26, v210, v234
    v_pk_mul_f16 v27, v211, v235
    v_smfmac_f32_16x16x64_bf16 v[132:135], v[108:111], v[36:43], v12
    buffer_load_dwordx4 v[148:151], v11, s[20:23], 0 offen
    s_waitcnt lgkmcnt(1)
    v_exp_f32_e32 v128, v128
    v_mfma_f32_16x16x32_f16 v[136:139], v[92:95], v[24:27], 0
    ds_read_b128 v[196:199], v3 offset:4384
    v_pk_mul_f16 v20, v212, v236
    v_pk_mul_f16 v21, v213, v237
    v_mfma_f32_32x32x16_f16 v[36:51], v[84:87], v[24:27], v[68:83]
    v_pk_mul_f16 v22, v214, v238
    v_pk_mul_f16 v23, v215, v239
    v_add_f32_e64 v52, |v52|, |v60|
    v_add_f32_e64 v53, |v53|, |v61|
    v_add_f32_e64 v54, |v54|, |v62|
    v_add_f32_e64 v55, |v55|, |v63|
    v_mfma_f32_32x32x16_f16 v[36:51], v[88:91], v[20:23], v[36:51]
    v_add_f32_e64 v56, |v56|, |v64|
    v_add_f32_e64 v57, |v57|, |v65|
    v_add_f32_e64 v58, |v58|, |v66|
    v_fma_f32 v59, |v59|, v118, |v67|
    v_pk_mul_f16 v24, v200, v240
    v_pk_mul_f16 v25, v201, v241
    v_mfma_f32_16x16x32_f16 v[136:139], v[96:99], v[20:23], v[136:139]
    v_pk_mul_f16 v26, v202, v242
    v_pk_mul_f16 v27, v203, v243
    v_smfmac_f32_16x16x64_bf16 v[132:135], v[112:115], v[52:59], v12
    s_waitcnt vmcnt(3) lgkmcnt(0)
    v_add_f32_e32 v16, v16, v128
    v_mfma_f32_16x16x32_f16 v[136:139], v[100:103], v[24:27], v[136:139]
    v_pk_mul_f16 v20, v204, v244
    v_pk_mul_f16 v21, v205, v245
    v_mfma_f32_32x32x16_f16 v[52:67], v[84:87], v[24:27], v[68:83]
    v_pk_mul_f16 v22, v206, v246
    v_pk_mul_f16 v23, v207, v247
    v_add_f32_e64 v36, |v36|, |v44|
    v_add_f32_e64 v37, |v37|, |v45|
    v_add_f32_e64 v38, |v38|, |v46|
    v_add_f32_e64 v39, |v39|, |v47|
    v_mfma_f32_32x32x16_f16 v[52:67], v[88:91], v[20:23], v[52:67]
    v_add_f32_e64 v40, |v40|, |v48|
    v_add_f32_e64 v41, |v41|, |v49|
    v_add_f32_e64 v42, |v42|, |v50|
    v_fma_f32 v43, |v43|, v118, |v51|
    v_pk_mul_f16 v24, v240, v192
    v_pk_mul_f16 v25, v241, v193
    v_mfma_f32_16x16x32_f16 v[136:139], v[104:107], v[20:23], v[136:139]
    v_pk_mul_f16 v26, v242, v194
    v_pk_mul_f16 v27, v243, v195
    v_mfma_f32_4x4x4_16b_bf16 v[120:123], v[116:117], v[152:153], 0
    v_fmac_f32_e64 v17, v128, v129
    v_mfma_f32_4x4x4_16b_bf16 v[124:127], v[116:117], v[154:155], 0
    v_exp_f32_e64 v132, v132
    v_smfmac_f32_16x16x64_bf16 v[136:139], v[108:111], v[36:43], v12
    v_add_f32_e64 v16, v16, v132
    v_cvt_pk_f16_f32 v120, v120, v121
    v_cvt_pk_f16_f32 v121, v122, v123
    v_cvt_pk_f16_f32 v122, v124, v125
    v_cvt_pk_f16_f32 v123, v126, v127
    v_mfma_f32_16x16x32_f16 v[140:143], v[92:95], v[24:27], 0
    ds_write_b128 v9, v[120:123] offset:6528
    v_pk_mul_f16 v20, v244, v196
    v_pk_mul_f16 v21, v245, v197
    v_mfma_f32_32x32x16_f16 v[36:51], v[84:87], v[24:27], v[68:83]
    v_pk_mul_f16 v22, v246, v198
    v_pk_mul_f16 v23, v247, v199
    v_add_f32_e64 v52, |v52|, |v60|
    v_add_f32_e64 v53, |v53|, |v61|
    v_add_f32_e64 v54, |v54|, |v62|
    v_add_f32_e64 v55, |v55|, |v63|
    v_mfma_f32_32x32x16_f16 v[36:51], v[88:91], v[20:23], v[36:51]
    v_add_f32_e64 v56, |v56|, |v64|
    v_add_f32_e64 v57, |v57|, |v65|
    v_add_f32_e64 v58, |v58|, |v66|
    v_fma_f32 v59, |v59|, v118, |v67|
    v_pk_mul_f16 v24, v200, v192
    v_pk_mul_f16 v25, v201, v193
    v_mfma_f32_16x16x32_f16 v[140:143], v[96:99], v[20:23], v[140:143]
    ds_read_b128 v[168:171], v6 offset:6528
    v_pk_mul_f16 v26, v202, v194
    v_pk_mul_f16 v27, v203, v195
    v_smfmac_f32_16x16x64_bf16 v[136:139], v[112:115], v[52:59], v12
    ds_read_b128 v[172:175], v6 offset:6560
    v_fmac_f32_e64 v17, v132, v133
    v_add_u32_dpp v11, v35, v10 quad_perm:[1,1,1,1] row_mask:0xf bank_mask:0xf
    v_mfma_f32_16x16x32_f16 v[140:143], v[100:103], v[24:27], v[140:143]
    ds_read_b128 v[184:187], v6 offset:6800
    v_pk_mul_f16 v20, v204, v196
    v_pk_mul_f16 v21, v205, v197
    v_mfma_f32_32x32x16_f16 v[52:67], v[84:87], v[24:27], v[68:83]
    v_pk_mul_f16 v22, v206, v198
    v_pk_mul_f16 v23, v207, v199
    v_add_f32_e64 v36, |v36|, |v44|
    v_add_f32_e64 v37, |v37|, |v45|
    v_add_f32_e64 v38, |v38|, |v46|
    v_add_f32_e64 v39, |v39|, |v47|
    v_mfma_f32_32x32x16_f16 v[52:67], v[88:91], v[20:23], v[52:67]
    v_add_f32_e64 v40, |v40|, |v48|
    v_add_f32_e64 v41, |v41|, |v49|
    v_add_f32_e64 v42, |v42|, |v50|
    v_fma_f32 v43, |v43|, v118, |v51|
    v_pk_mul_f16 v24, v208, v160
    v_pk_mul_f16 v25, v209, v161
    v_mfma_f32_16x16x32_f16 v[140:143], v[104:107], v[20:23], v[140:143]
    ds_read_b128 v[188:191], v6 offset:6832
    v_pk_mul_f16 v26, v210, v162
    v_pk_mul_f16 v27, v211, v163
    v_smfmac_f32_16x16x64_bf16 v[140:143], v[108:111], v[36:43], v12
    buffer_load_dwordx4 v[152:155], v11, s[20:23], 0 offen
    v_exp_f32_e64 v136, v136
    v_mfma_f32_16x16x32_f16 v[128:131], v[92:95], v[24:27], 0
    ds_read_b128 v[176:179], v7 offset:4352
    v_pk_mul_f16 v20, v212, v164
    v_pk_mul_f16 v21, v213, v165
    v_mfma_f32_32x32x16_f16 v[36:51], v[84:87], v[24:27], v[68:83]
    v_pk_mul_f16 v22, v214, v166
    v_pk_mul_f16 v23, v215, v167
    v_add_f32_e64 v52, |v52|, |v60|
    v_add_f32_e64 v53, |v53|, |v61|
    v_add_f32_e64 v54, |v54|, |v62|
    v_add_f32_e64 v55, |v55|, |v63|
    v_mfma_f32_32x32x16_f16 v[36:51], v[88:91], v[20:23], v[36:51]
    v_add_f32_e64 v56, |v56|, |v64|
    v_add_f32_e64 v57, |v57|, |v65|
    v_add_f32_e64 v58, |v58|, |v66|
    v_fma_f32 v59, |v59|, v118, |v67|
    v_pk_mul_f16 v24, v208, v216
    v_pk_mul_f16 v25, v209, v217
    v_mfma_f32_16x16x32_f16 v[128:131], v[96:99], v[20:23], v[128:131]
    ds_read_b128 v[180:183], v7 offset:4384
    v_pk_mul_f16 v26, v210, v218
    v_pk_mul_f16 v27, v211, v219
    v_smfmac_f32_16x16x64_bf16 v[140:143], v[112:115], v[52:59], v12
    ds_read_b128 v[224:227], v8 offset:5440
    s_waitcnt vmcnt(3) lgkmcnt(4)
    v_add_f32_e32 v16, v16, v136
    v_mfma_f32_16x16x32_f16 v[128:131], v[100:103], v[24:27], v[128:131]
    v_pk_mul_f16 v20, v212, v220
    v_pk_mul_f16 v21, v213, v221
    v_mfma_f32_32x32x16_f16 v[52:67], v[84:87], v[24:27], v[68:83]
    v_pk_mul_f16 v22, v214, v222
    v_pk_mul_f16 v23, v215, v223
    v_add_f32_e64 v36, |v36|, |v44|
    v_add_f32_e64 v37, |v37|, |v45|
    v_add_f32_e64 v38, |v38|, |v46|
    v_add_f32_e64 v39, |v39|, |v47|
    v_mfma_f32_32x32x16_f16 v[52:67], v[88:91], v[20:23], v[52:67]
    v_add_f32_e64 v40, |v40|, |v48|
    v_add_f32_e64 v41, |v41|, |v49|
    v_add_f32_e64 v42, |v42|, |v50|
    v_fma_f32 v43, |v43|, v118, |v51|
    v_pk_mul_f16 v24, v168, v160
    v_pk_mul_f16 v25, v169, v161
    v_mfma_f32_16x16x32_f16 v[128:131], v[104:107], v[20:23], v[128:131]
    v_pk_mul_f16 v26, v170, v162
    v_pk_mul_f16 v27, v171, v163
    v_mfma_f32_4x4x4_16b_bf16 v[120:123], v[116:117], v[156:157], 0
    v_fmac_f32_e64 v17, v136, v137
    v_mfma_f32_4x4x4_16b_bf16 v[124:127], v[116:117], v[158:159], 0
    v_exp_f32_e64 v140, v140
    v_smfmac_f32_16x16x64_bf16 v[128:131], v[108:111], v[36:43], v12
    ds_read_b128 v[228:231], v8 offset:5472
    s_waitcnt lgkmcnt(3)
    v_add_f32_e32 v16, v16, v140
    v_cvt_pk_f16_f32 v120, v120, v121
    v_cvt_pk_f16_f32 v121, v122, v123
    v_cvt_pk_f16_f32 v122, v124, v125
    v_cvt_pk_f16_f32 v123, v126, v127
    v_mfma_f32_16x16x32_f16 v[132:135], v[92:95], v[24:27], 0
    ds_write_b128 v9, v[120:123] offset:0
    v_pk_mul_f16 v20, v172, v164
    v_pk_mul_f16 v21, v173, v165
    v_mfma_f32_32x32x16_f16 v[36:51], v[84:87], v[24:27], v[68:83]
    v_pk_mul_f16 v22, v174, v166
    v_pk_mul_f16 v23, v175, v167
    v_add_f32_e64 v52, |v52|, |v60|
    v_add_f32_e64 v53, |v53|, |v61|
    v_add_f32_e64 v54, |v54|, |v62|
    v_add_f32_e64 v55, |v55|, |v63|
    v_mfma_f32_32x32x16_f16 v[36:51], v[88:91], v[20:23], v[36:51]
    v_add_f32_e64 v56, |v56|, |v64|
    v_add_f32_e64 v57, |v57|, |v65|
    v_add_f32_e64 v58, |v58|, |v66|
    v_fma_f32 v59, |v59|, v118, |v67|
    v_pk_mul_f16 v24, v184, v160
    v_pk_mul_f16 v25, v185, v161
    v_mfma_f32_16x16x32_f16 v[132:135], v[96:99], v[20:23], v[132:135]
    v_pk_mul_f16 v26, v186, v162
    v_pk_mul_f16 v27, v187, v163
    v_smfmac_f32_16x16x64_bf16 v[128:131], v[112:115], v[52:59], v12
    s_waitcnt vmcnt(2)
    v_fmac_f32_e32 v17, v140, v141
    v_mfma_f32_16x16x32_f16 v[132:135], v[100:103], v[24:27], v[132:135]
    v_pk_mul_f16 v20, v188, v164
    v_pk_mul_f16 v21, v189, v165
    v_mfma_f32_32x32x16_f16 v[52:67], v[84:87], v[24:27], v[68:83]
    v_pk_mul_f16 v22, v190, v166
    v_pk_mul_f16 v23, v191, v167
    v_add_f32_e64 v36, |v36|, |v44|
    v_add_f32_e64 v37, |v37|, |v45|
    v_add_f32_e64 v38, |v38|, |v46|
    v_add_f32_e64 v39, |v39|, |v47|
    v_mfma_f32_32x32x16_f16 v[52:67], v[88:91], v[20:23], v[52:67]
    v_add_f32_e64 v40, |v40|, |v48|
    v_add_f32_e64 v41, |v41|, |v49|
    v_add_f32_e64 v42, |v42|, |v50|
    v_fma_f32 v43, |v43|, v118, |v51|
    v_pk_mul_f16 v24, v168, v216
    v_pk_mul_f16 v25, v169, v217
    v_mfma_f32_16x16x32_f16 v[132:135], v[104:107], v[20:23], v[132:135]
    v_pk_mul_f16 v26, v170, v218
    v_pk_mul_f16 v27, v171, v219
    v_mfma_f32_4x4x4_16b_bf16 v[120:123], v[116:117], v[144:145], 0
    v_exp_f32_e64 v128, v128
    v_mfma_f32_4x4x4_16b_bf16 v[124:127], v[116:117], v[146:147], 0
    v_add_f32_e64 v16, v16, v128
    v_smfmac_f32_16x16x64_bf16 v[132:135], v[108:111], v[36:43], v12
    v_fmac_f32_e64 v17, v128, v129
    v_cvt_pk_f16_f32 v120, v120, v121
    v_cvt_pk_f16_f32 v121, v122, v123
    v_cvt_pk_f16_f32 v122, v124, v125
    v_cvt_pk_f16_f32 v123, v126, v127
    v_mfma_f32_16x16x32_f16 v[136:139], v[92:95], v[24:27], 0
    ds_write_b128 v9, v[120:123] offset:1088
    v_pk_mul_f16 v20, v172, v220
    v_pk_mul_f16 v21, v173, v221
    v_mfma_f32_32x32x16_f16 v[36:51], v[84:87], v[24:27], v[68:83]
    v_pk_mul_f16 v22, v174, v222
    v_pk_mul_f16 v23, v175, v223
    v_add_f32_e64 v52, |v52|, |v60|
    v_add_f32_e64 v53, |v53|, |v61|
    v_add_f32_e64 v54, |v54|, |v62|
    v_add_f32_e64 v55, |v55|, |v63|
    v_mfma_f32_32x32x16_f16 v[36:51], v[88:91], v[20:23], v[36:51]
    v_add_f32_e64 v56, |v56|, |v64|
    v_add_f32_e64 v57, |v57|, |v65|
    v_add_f32_e64 v58, |v58|, |v66|
    v_fma_f32 v59, |v59|, v118, |v67|
    v_pk_mul_f16 v24, v184, v216
    v_pk_mul_f16 v25, v185, v217
    v_mfma_f32_16x16x32_f16 v[136:139], v[96:99], v[20:23], v[136:139]
    ds_read_b128 v[248:251], v1 offset:0
    v_pk_mul_f16 v26, v186, v218
    v_pk_mul_f16 v27, v187, v219
    v_smfmac_f32_16x16x64_bf16 v[132:135], v[112:115], v[52:59], v12
    ds_read_b128 v[252:255], v1 offset:32
    v_mfma_f32_16x16x32_f16 v[136:139], v[100:103], v[24:27], v[136:139]
    ds_read_b128 v[232:235], v2 offset:0
    v_pk_mul_f16 v20, v188, v220
    v_pk_mul_f16 v21, v189, v221
    v_mfma_f32_32x32x16_f16 v[52:67], v[84:87], v[24:27], v[68:83]
    v_pk_mul_f16 v22, v190, v222
    v_pk_mul_f16 v23, v191, v223
    v_add_f32_e64 v36, |v36|, |v44|
    v_add_f32_e64 v37, |v37|, |v45|
    v_add_f32_e64 v38, |v38|, |v46|
    v_add_f32_e64 v39, |v39|, |v47|
    v_mfma_f32_32x32x16_f16 v[52:67], v[88:91], v[20:23], v[52:67]
    v_add_f32_e64 v40, |v40|, |v48|
    v_add_f32_e64 v41, |v41|, |v49|
    v_add_f32_e64 v42, |v42|, |v50|
    v_fma_f32 v43, |v43|, v118, |v51|
    v_pk_mul_f16 v24, v168, v200
    v_pk_mul_f16 v25, v169, v201
    v_mfma_f32_16x16x32_f16 v[136:139], v[104:107], v[20:23], v[136:139]
    v_pk_mul_f16 v26, v170, v202
    v_pk_mul_f16 v27, v171, v203
    v_smfmac_f32_16x16x64_bf16 v[136:139], v[108:111], v[36:43], v12
    ds_read_b128 v[236:239], v2 offset:32
    s_waitcnt vmcnt(1)
    v_exp_f32_e32 v132, v132
    v_mfma_f32_16x16x32_f16 v[140:143], v[92:95], v[24:27], 0
    v_pk_mul_f16 v20, v172, v204
    v_pk_mul_f16 v21, v173, v205
    v_mfma_f32_32x32x16_f16 v[36:51], v[84:87], v[24:27], v[68:83]
    v_pk_mul_f16 v22, v174, v206
    v_pk_mul_f16 v23, v175, v207
    v_add_f32_e64 v52, |v52|, |v60|
    v_add_f32_e64 v53, |v53|, |v61|
    v_add_f32_e64 v54, |v54|, |v62|
    v_add_f32_e64 v55, |v55|, |v63|
    v_mfma_f32_32x32x16_f16 v[36:51], v[88:91], v[20:23], v[36:51]
    v_add_f32_e64 v56, |v56|, |v64|
    v_add_f32_e64 v57, |v57|, |v65|
    v_add_f32_e64 v58, |v58|, |v66|
    v_fma_f32 v59, |v59|, v118, |v67|
    v_pk_mul_f16 v24, v184, v200
    v_pk_mul_f16 v25, v185, v201
    v_mfma_f32_16x16x32_f16 v[140:143], v[96:99], v[20:23], v[140:143]
    v_pk_mul_f16 v26, v186, v202
    v_pk_mul_f16 v27, v187, v203
    v_mfma_f32_4x4x4_16b_bf16 v[120:123], v[116:117], v[148:149], 0
    v_add_f32_e64 v16, v16, v132
    v_mfma_f32_4x4x4_16b_bf16 v[124:127], v[116:117], v[150:151], 0
    v_fmac_f32_e64 v17, v132, v133
    v_smfmac_f32_16x16x64_bf16 v[136:139], v[112:115], v[52:59], v12
    ds_read_b128 v[240:243], v3 offset:0
    s_waitcnt lgkmcnt(2)
    s_nop 0
    v_add_u32_dpp v11, v34, v10 quad_perm:[2,2,2,2] row_mask:0xf bank_mask:0xf
    v_cvt_pk_f16_f32 v120, v120, v121
    v_cvt_pk_f16_f32 v121, v122, v123
    v_cvt_pk_f16_f32 v122, v124, v125
    v_cvt_pk_f16_f32 v123, v126, v127
    v_mfma_f32_16x16x32_f16 v[140:143], v[100:103], v[24:27], v[140:143]
    ds_write_b128 v9, v[120:123] offset:2176
    v_pk_mul_f16 v20, v188, v204
    v_pk_mul_f16 v21, v189, v205
    v_mfma_f32_32x32x16_f16 v[52:67], v[84:87], v[24:27], v[68:83]
    v_pk_mul_f16 v22, v190, v206
    v_pk_mul_f16 v23, v191, v207
    v_add_f32_e64 v36, |v36|, |v44|
    v_add_f32_e64 v37, |v37|, |v45|
    v_add_f32_e64 v38, |v38|, |v46|
    v_add_f32_e64 v39, |v39|, |v47|
    v_mfma_f32_32x32x16_f16 v[52:67], v[88:91], v[20:23], v[52:67]
    v_add_f32_e64 v40, |v40|, |v48|
    v_add_f32_e64 v41, |v41|, |v49|
    v_add_f32_e64 v42, |v42|, |v50|
    v_fma_f32 v43, |v43|, v118, |v51|
    v_pk_mul_f16 v24, v176, v224
    v_pk_mul_f16 v25, v177, v225
    v_mfma_f32_16x16x32_f16 v[140:143], v[104:107], v[20:23], v[140:143]
    v_pk_mul_f16 v26, v178, v226
    v_pk_mul_f16 v27, v179, v227
    v_smfmac_f32_16x16x64_bf16 v[140:143], v[108:111], v[36:43], v12
    buffer_load_dwordx4 v[156:159], v11, s[20:23], 0 offen
    s_waitcnt lgkmcnt(2)
    v_exp_f32_e32 v136, v136
    v_mfma_f32_16x16x32_f16 v[128:131], v[92:95], v[24:27], 0
    ds_read_b128 v[244:247], v3 offset:32
    v_pk_mul_f16 v20, v180, v228
    v_pk_mul_f16 v21, v181, v229
    v_mfma_f32_32x32x16_f16 v[36:51], v[84:87], v[24:27], v[68:83]
    v_pk_mul_f16 v22, v182, v230
    v_pk_mul_f16 v23, v183, v231
    v_add_f32_e64 v52, |v52|, |v60|
    v_add_f32_e64 v53, |v53|, |v61|
    v_add_f32_e64 v54, |v54|, |v62|
    v_add_f32_e64 v55, |v55|, |v63|
    v_mfma_f32_32x32x16_f16 v[36:51], v[88:91], v[20:23], v[36:51]
    v_add_f32_e64 v56, |v56|, |v64|
    v_add_f32_e64 v57, |v57|, |v65|
    v_add_f32_e64 v58, |v58|, |v66|
    v_fma_f32 v59, |v59|, v118, |v67|
    v_pk_mul_f16 v24, v248, v232
    v_pk_mul_f16 v25, v249, v233
    v_mfma_f32_16x16x32_f16 v[128:131], v[96:99], v[20:23], v[128:131]
    v_pk_mul_f16 v26, v250, v234
    v_pk_mul_f16 v27, v251, v235
    v_smfmac_f32_16x16x64_bf16 v[140:143], v[112:115], v[52:59], v12
    ds_read_b128 v[192:195], v4 offset:2176
    s_waitcnt lgkmcnt(1)
    v_add_f32_e32 v16, v16, v136
    v_fmac_f32_e64 v17, v136, v137
    v_mfma_f32_16x16x32_f16 v[132:135], v[92:95], v[24:27], 0
    v_pk_mul_f16 v20, v252, v236
    v_pk_mul_f16 v21, v253, v237
    v_mfma_f32_32x32x16_f16 v[52:67], v[84:87], v[24:27], v[68:83]
    v_pk_mul_f16 v22, v254, v238
    v_pk_mul_f16 v23, v255, v239
    v_add_f32_e64 v36, |v36|, |v44|
    v_add_f32_e64 v37, |v37|, |v45|
    v_add_f32_e64 v38, |v38|, |v46|
    v_add_f32_e64 v39, |v39|, |v47|
    v_mfma_f32_32x32x16_f16 v[52:67], v[88:91], v[20:23], v[52:67]
    v_add_f32_e64 v40, |v40|, |v48|
    v_add_f32_e64 v41, |v41|, |v49|
    v_add_f32_e64 v42, |v42|, |v50|
    v_fma_f32 v43, |v43|, v118, |v51|
    v_pk_mul_f16 v24, v232, v240
    v_pk_mul_f16 v25, v233, v241
    v_mfma_f32_16x16x32_f16 v[132:135], v[96:99], v[20:23], v[132:135]
    v_pk_mul_f16 v26, v234, v242
    v_pk_mul_f16 v27, v235, v243
    v_smfmac_f32_16x16x64_bf16 v[128:131], v[28:31], v[36:43], v12
    ds_read_b128 v[196:199], v4 offset:2208
    s_waitcnt vmcnt(1)
    v_exp_f32_e32 v140, v140
    v_mfma_f32_16x16x32_f16 v[132:135], v[100:103], v[24:27], v[132:135]
    ds_read_b128 v[208:211], v5 offset:0
    v_pk_mul_f16 v20, v236, v244
    v_pk_mul_f16 v21, v237, v245
    v_mfma_f32_32x32x16_f16 v[36:51], v[84:87], v[24:27], v[68:83]
    v_pk_mul_f16 v22, v238, v246
    v_pk_mul_f16 v23, v239, v247
    v_add_f32_e64 v52, |v52|, |v60|
    v_add_f32_e64 v53, |v53|, |v61|
    v_add_f32_e64 v54, |v54|, |v62|
    v_add_f32_e64 v55, |v55|, |v63|
    v_mfma_f32_32x32x16_f16 v[36:51], v[88:91], v[20:23], v[36:51]
    v_add_f32_e64 v56, |v56|, |v64|
    v_add_f32_e64 v57, |v57|, |v65|
    v_add_f32_e64 v58, |v58|, |v66|
    v_fma_f32 v59, |v59|, v118, |v67|
    v_pk_mul_f16 v24, v248, v240
    v_pk_mul_f16 v25, v249, v241
    v_mfma_f32_16x16x32_f16 v[132:135], v[104:107], v[20:23], v[132:135]
    v_pk_mul_f16 v26, v250, v242
    v_pk_mul_f16 v27, v251, v243
    v_mfma_f32_4x4x4_16b_bf16 v[120:123], v[116:117], v[152:153], 0
    v_add_f32_e64 v16, v16, v140
    v_mfma_f32_4x4x4_16b_bf16 v[124:127], v[116:117], v[154:155], 0
    v_fmac_f32_e64 v17, v140, v141
    v_smfmac_f32_16x16x64_bf16 v[132:135], v[108:111], v[52:59], v12
    ds_read_b128 v[212:215], v5 offset:32
    s_waitcnt lgkmcnt(2)
    v_add_f32_e32 v128, v128, v13
    v_cvt_pk_f16_f32 v120, v120, v121
    v_cvt_pk_f16_f32 v121, v122, v123
    v_cvt_pk_f16_f32 v122, v124, v125
    v_cvt_pk_f16_f32 v123, v126, v127
    v_mfma_f32_16x16x32_f16 v[136:139], v[92:95], v[24:27], 0
    ds_write_b128 v9, v[120:123] offset:3264
    v_pk_mul_f16 v20, v252, v244
    v_pk_mul_f16 v21, v253, v245
    v_mfma_f32_32x32x16_f16 v[52:67], v[84:87], v[24:27], v[68:83]
    v_pk_mul_f16 v22, v254, v246
    v_pk_mul_f16 v23, v255, v247
    v_add_f32_e64 v36, |v36|, |v44|
    v_add_f32_e64 v37, |v37|, |v45|
    v_add_f32_e64 v38, |v38|, |v46|
    v_add_f32_e64 v39, |v39|, |v47|
    v_mfma_f32_32x32x16_f16 v[52:67], v[88:91], v[20:23], v[52:67]
    v_add_f32_e64 v40, |v40|, |v48|
    v_add_f32_e64 v41, |v41|, |v49|
    v_add_f32_e64 v42, |v42|, |v50|
    v_fma_f32 v43, |v43|, v118, |v51|
    v_pk_mul_f16 v24, v192, v248
    v_pk_mul_f16 v25, v193, v249
    v_mfma_f32_16x16x32_f16 v[136:139], v[96:99], v[20:23], v[136:139]
    v_pk_mul_f16 v26, v194, v250
    v_pk_mul_f16 v27, v195, v251
    v_smfmac_f32_16x16x64_bf16 v[132:135], v[112:115], v[36:43], v12
    ds_read_b128 v[160:163], v4 offset:3264
    v_exp_f32_e64 v128, v128
    v_cmp_gt_f32_e64 s[50:51], s29, v129
    v_add_f32_e64 v16, v16, v128
    v_mfma_f32_16x16x32_f16 v[136:139], v[100:103], v[24:27], v[136:139]
    ds_read_b128 v[164:167], v4 offset:3296
    v_pk_mul_f16 v20, v196, v252
    v_pk_mul_f16 v21, v197, v253
    v_mfma_f32_32x32x16_f16 v[36:51], v[84:87], v[24:27], v[68:83]
    v_pk_mul_f16 v22, v198, v254
    v_pk_mul_f16 v23, v199, v255
    v_add_f32_e64 v52, |v52|, |v60|
    v_add_f32_e64 v53, |v53|, |v61|
    v_add_f32_e64 v54, |v54|, |v62|
    v_add_f32_e64 v55, |v55|, |v63|
    v_mfma_f32_32x32x16_f16 v[36:51], v[88:91], v[20:23], v[36:51]
    v_add_f32_e64 v56, |v56|, |v64|
    v_add_f32_e64 v57, |v57|, |v65|
    v_add_f32_e64 v58, |v58|, |v66|
    v_fma_f32 v59, |v59|, v118, |v67|
    v_pk_mul_f16 v24, v192, v232
    v_pk_mul_f16 v25, v193, v233
    v_mfma_f32_16x16x32_f16 v[136:139], v[104:107], v[20:23], v[136:139]
    ds_read_b128 v[216:219], v1 offset:2176
    v_pk_mul_f16 v26, v194, v234
    v_pk_mul_f16 v27, v195, v235
    v_smfmac_f32_16x16x64_bf16 v[136:139], v[108:111], v[52:59], v12
    ds_read_b128 v[220:223], v1 offset:2208
    v_fmac_f32_e64 v17, v128, v129
    v_exp_f32_e64 v18, v132
    v_mfma_f32_16x16x32_f16 v[140:143], v[92:95], v[24:27], 0
    ds_read_b128 v[168:171], v2 offset:2176
    v_pk_mul_f16 v20, v196, v236
    v_pk_mul_f16 v21, v197, v237
    v_mfma_f32_32x32x16_f16 v[52:67], v[84:87], v[24:27], v[68:83]
    v_pk_mul_f16 v22, v198, v238
    v_pk_mul_f16 v23, v199, v239
    v_add_f32_e64 v36, |v36|, |v44|
    v_add_f32_e64 v37, |v37|, |v45|
    v_add_f32_e64 v38, |v38|, |v46|
    v_add_f32_e64 v39, |v39|, |v47|
    v_mfma_f32_32x32x16_f16 v[52:67], v[88:91], v[20:23], v[52:67]
    v_add_f32_e64 v40, |v40|, |v48|
    v_add_f32_e64 v41, |v41|, |v49|
    v_add_f32_e64 v42, |v42|, |v50|
    v_fma_f32 v43, |v43|, v118, |v51|
    v_pk_mul_f16 v24, v192, v240
    v_pk_mul_f16 v25, v193, v241
    v_mfma_f32_16x16x32_f16 v[140:143], v[96:99], v[20:23], v[140:143]
    v_pk_mul_f16 v26, v194, v242
    v_pk_mul_f16 v27, v195, v243
    v_smfmac_f32_16x16x64_bf16 v[136:139], v[112:115], v[36:43], v12
    ds_read_b128 v[172:175], v2 offset:2208
    s_waitcnt lgkmcnt(4)
    s_nop 0
    v_cmp_le_f32_e64 s[34:35], s31, |v133|
    v_mfma_f32_16x16x32_f16 v[140:143], v[100:103], v[24:27], v[140:143]
    v_pk_mul_f16 v20, v196, v244
    v_pk_mul_f16 v21, v197, v245
    v_mfma_f32_32x32x16_f16 v[36:51], v[84:87], v[24:27], v[68:83]
    v_pk_mul_f16 v22, v198, v246
    v_pk_mul_f16 v23, v199, v247
    v_add_f32_e64 v52, |v52|, |v60|
    v_add_f32_e64 v53, |v53|, |v61|
    v_add_f32_e64 v54, |v54|, |v62|
    v_add_f32_e64 v55, |v55|, |v63|
    v_mfma_f32_32x32x16_f16 v[36:51], v[88:91], v[20:23], v[36:51]
    v_add_f32_e64 v56, |v56|, |v64|
    v_add_f32_e64 v57, |v57|, |v65|
    v_add_f32_e64 v58, |v58|, |v66|
    v_fma_f32 v59, |v59|, v118, |v67|
    v_pk_mul_f16 v24, v192, v208
    v_pk_mul_f16 v25, v193, v209
    v_mfma_f32_16x16x32_f16 v[140:143], v[104:107], v[20:23], v[140:143]
    v_pk_mul_f16 v26, v194, v210
    v_pk_mul_f16 v27, v195, v211
    v_smfmac_f32_16x16x64_bf16 v[140:143], v[108:111], v[52:59], v12
    ds_read_b128 v[184:187], v3 offset:2176
    v_mul_f32_e64 v19, v18, v133
    v_exp_f32_e64 v136, v136
    v_add_u32_dpp v11, v35, v10 quad_perm:[2,2,2,2] row_mask:0xf bank_mask:0xf
    v_mfma_f32_16x16x32_f16 v[128:131], v[92:95], v[24:27], 0
    v_pk_mul_f16 v20, v196, v212
    v_pk_mul_f16 v21, v197, v213
    v_mfma_f32_32x32x16_f16 v[52:67], v[84:87], v[24:27], v[68:83]
    v_pk_mul_f16 v22, v198, v214
    v_pk_mul_f16 v23, v199, v215
    v_add_f32_e64 v36, |v36|, |v44|
    v_add_f32_e64 v37, |v37|, |v45|
    v_add_f32_e64 v38, |v38|, |v46|
    v_add_f32_e64 v39, |v39|, |v47|
    v_mfma_f32_32x32x16_f16 v[52:67], v[88:91], v[20:23], v[52:67]
    v_add_f32_e64 v40, |v40|, |v48|
    v_add_f32_e64 v41, |v41|, |v49|
    v_add_f32_e64 v42, |v42|, |v50|
    v_fma_f32 v43, |v43|, v118, |v51|
    v_pk_mul_f16 v24, v160, v248
    v_pk_mul_f16 v25, v161, v249
    v_mfma_f32_16x16x32_f16 v[128:131], v[96:99], v[20:23], v[128:131]
    v_pk_mul_f16 v26, v162, v250
    v_pk_mul_f16 v27, v163, v251
    v_smfmac_f32_16x16x64_bf16 v[140:143], v[112:115], v[36:43], v12
    buffer_load_dwordx4 v[144:147], v11, s[20:23], 0 offen
    v_add_f32_e64 v18, v18, v136
    v_fmac_f32_e64 v19, v136, v137
    v_mfma_f32_16x16x32_f16 v[128:131], v[100:103], v[24:27], v[128:131]
    ds_read_b128 v[188:191], v3 offset:2208
    v_pk_mul_f16 v20, v164, v252
    v_pk_mul_f16 v21, v165, v253
    v_mfma_f32_32x32x16_f16 v[36:51], v[84:87], v[24:27], v[68:83]
    v_pk_mul_f16 v22, v166, v254
    v_pk_mul_f16 v23, v167, v255
    v_add_f32_e64 v52, |v52|, |v60|
    v_add_f32_e64 v53, |v53|, |v61|
    v_add_f32_e64 v54, |v54|, |v62|
    v_add_f32_e64 v55, |v55|, |v63|
    v_mfma_f32_32x32x16_f16 v[36:51], v[88:91], v[20:23], v[36:51]
    v_add_f32_e64 v56, |v56|, |v64|
    v_add_f32_e64 v57, |v57|, |v65|
    v_add_f32_e64 v58, |v58|, |v66|
    v_fma_f32 v59, |v59|, v118, |v67|
    v_pk_mul_f16 v24, v160, v232
    v_pk_mul_f16 v25, v161, v233
    v_mfma_f32_16x16x32_f16 v[128:131], v[104:107], v[20:23], v[128:131]
    v_pk_mul_f16 v26, v162, v234
    v_pk_mul_f16 v27, v163, v235
    v_smfmac_f32_16x16x64_bf16 v[128:131], v[108:111], v[52:59], v12
    ds_read_b128 v[200:203], v7 offset:0
    v_exp_f32_e64 v140, v140
    v_mfma_f32_16x16x32_f16 v[132:135], v[92:95], v[24:27], 0
    v_pk_mul_f16 v20, v164, v236
    v_pk_mul_f16 v21, v165, v237
    v_mfma_f32_32x32x16_f16 v[52:67], v[84:87], v[24:27], v[68:83]
    v_pk_mul_f16 v22, v166, v238
    v_pk_mul_f16 v23, v167, v239
    v_add_f32_e64 v36, |v36|, |v44|
    v_add_f32_e64 v37, |v37|, |v45|
    v_add_f32_e64 v38, |v38|, |v46|
    v_add_f32_e64 v39, |v39|, |v47|
    v_mfma_f32_32x32x16_f16 v[52:67], v[88:91], v[20:23], v[52:67]
    v_add_f32_e64 v40, |v40|, |v48|
    v_add_f32_e64 v41, |v41|, |v49|
    v_add_f32_e64 v42, |v42|, |v50|
    v_fma_f32 v43, |v43|, v118, |v51|
    v_pk_mul_f16 v24, v160, v240
    v_pk_mul_f16 v25, v161, v241
    v_mfma_f32_16x16x32_f16 v[132:135], v[96:99], v[20:23], v[132:135]
    v_pk_mul_f16 v26, v162, v242
    v_pk_mul_f16 v27, v163, v243
    v_smfmac_f32_16x16x64_bf16 v[128:131], v[112:115], v[36:43], v12
    ds_read_b128 v[204:207], v7 offset:32
    s_waitcnt vmcnt(1)
    v_add_f32_e32 v18, v18, v140
    v_mfma_f32_16x16x32_f16 v[132:135], v[100:103], v[24:27], v[132:135]
    v_pk_mul_f16 v20, v164, v244
    v_pk_mul_f16 v21, v165, v245
    v_mfma_f32_32x32x16_f16 v[36:51], v[84:87], v[24:27], v[68:83]
    v_pk_mul_f16 v22, v166, v246
    v_pk_mul_f16 v23, v167, v247
    v_add_f32_e64 v52, |v52|, |v60|
    v_add_f32_e64 v53, |v53|, |v61|
    v_add_f32_e64 v54, |v54|, |v62|
    v_add_f32_e64 v55, |v55|, |v63|
    v_mfma_f32_32x32x16_f16 v[36:51], v[88:91], v[20:23], v[36:51]
    v_add_f32_e64 v56, |v56|, |v64|
    v_add_f32_e64 v57, |v57|, |v65|
    v_add_f32_e64 v58, |v58|, |v66|
    v_fma_f32 v59, |v59|, v118, |v67|
    v_pk_mul_f16 v24, v160, v208
    v_pk_mul_f16 v25, v161, v209
    v_mfma_f32_16x16x32_f16 v[132:135], v[104:107], v[20:23], v[132:135]
    v_pk_mul_f16 v26, v162, v210
    v_pk_mul_f16 v27, v163, v211
    v_mfma_f32_4x4x4_16b_bf16 v[120:123], v[116:117], v[156:157], 0
    v_fmac_f32_e64 v19, v140, v141
    v_mfma_f32_4x4x4_16b_bf16 v[124:127], v[116:117], v[158:159], 0
    v_exp_f32_e64 v128, v128
    v_smfmac_f32_16x16x64_bf16 v[132:135], v[108:111], v[52:59], v12
    ds_read_b128 v[176:179], v7 offset:1088
    s_waitcnt lgkmcnt(2)
    v_add_f32_e32 v18, v18, v128
    v_cvt_pk_f16_f32 v120, v120, v121
    v_cvt_pk_f16_f32 v121, v122, v123
    v_cvt_pk_f16_f32 v122, v124, v125
    v_cvt_pk_f16_f32 v123, v126, v127
    v_mfma_f32_16x16x32_f16 v[136:139], v[92:95], v[24:27], 0
    ds_write_b128 v9, v[120:123] offset:4352
    v_pk_mul_f16 v20, v164, v212
    v_pk_mul_f16 v21, v165, v213
    v_mfma_f32_32x32x16_f16 v[52:67], v[84:87], v[24:27], v[68:83]
    v_pk_mul_f16 v22, v166, v214
    v_pk_mul_f16 v23, v167, v215
    v_add_f32_e64 v36, |v36|, |v44|
    v_add_f32_e64 v37, |v37|, |v45|
    v_add_f32_e64 v38, |v38|, |v46|
    v_add_f32_e64 v39, |v39|, |v47|
    v_mfma_f32_32x32x16_f16 v[52:67], v[88:91], v[20:23], v[52:67]
    v_add_f32_e64 v40, |v40|, |v48|
    v_add_f32_e64 v41, |v41|, |v49|
    v_add_f32_e64 v42, |v42|, |v50|
    v_fma_f32 v43, |v43|, v118, |v51|
    v_pk_mul_f16 v24, v216, v168
    v_pk_mul_f16 v25, v217, v169
    v_mfma_f32_16x16x32_f16 v[136:139], v[96:99], v[20:23], v[136:139]
    v_pk_mul_f16 v26, v218, v170
    v_pk_mul_f16 v27, v219, v171
    v_smfmac_f32_16x16x64_bf16 v[132:135], v[112:115], v[36:43], v12
    ds_read_b128 v[180:183], v7 offset:1120
    v_fmac_f32_e64 v19, v128, v129
    v_mfma_f32_16x16x32_f16 v[136:139], v[100:103], v[24:27], v[136:139]
    v_pk_mul_f16 v20, v220, v172
    v_pk_mul_f16 v21, v221, v173
    v_mfma_f32_32x32x16_f16 v[36:51], v[84:87], v[24:27], v[68:83]
    v_pk_mul_f16 v22, v222, v174
    v_pk_mul_f16 v23, v223, v175
    v_add_f32_e64 v52, |v52|, |v60|
    v_add_f32_e64 v53, |v53|, |v61|
    v_add_f32_e64 v54, |v54|, |v62|
    v_add_f32_e64 v55, |v55|, |v63|
    v_mfma_f32_32x32x16_f16 v[36:51], v[88:91], v[20:23], v[36:51]
    v_add_f32_e64 v56, |v56|, |v64|
    v_add_f32_e64 v57, |v57|, |v65|
    v_add_f32_e64 v58, |v58|, |v66|
    v_fma_f32 v59, |v59|, v118, |v67|
    v_pk_mul_f16 v24, v168, v184
    v_pk_mul_f16 v25, v169, v185
    v_mfma_f32_16x16x32_f16 v[136:139], v[104:107], v[20:23], v[136:139]
    v_pk_mul_f16 v26, v170, v186
    v_pk_mul_f16 v27, v171, v187
    v_smfmac_f32_16x16x64_bf16 v[136:139], v[108:111], v[52:59], v12
    ds_read_b128 v[224:227], v4 offset:4352
    v_exp_f32_e64 v132, v132
    v_mfma_f32_16x16x32_f16 v[140:143], v[92:95], v[24:27], 0
    v_pk_mul_f16 v20, v172, v188
    v_pk_mul_f16 v21, v173, v189
    v_mfma_f32_32x32x16_f16 v[52:67], v[84:87], v[24:27], v[68:83]
    v_pk_mul_f16 v22, v174, v190
    v_pk_mul_f16 v23, v175, v191
    v_add_f32_e64 v36, |v36|, |v44|
    v_add_f32_e64 v37, |v37|, |v45|
    v_add_f32_e64 v38, |v38|, |v46|
    v_add_f32_e64 v39, |v39|, |v47|
    v_mfma_f32_32x32x16_f16 v[52:67], v[88:91], v[20:23], v[52:67]
    v_add_f32_e64 v40, |v40|, |v48|
    v_add_f32_e64 v41, |v41|, |v49|
    v_add_f32_e64 v42, |v42|, |v50|
    v_fma_f32 v43, |v43|, v118, |v51|
    v_pk_mul_f16 v24, v216, v184
    v_pk_mul_f16 v25, v217, v185
    v_mfma_f32_16x16x32_f16 v[140:143], v[96:99], v[20:23], v[140:143]
    v_pk_mul_f16 v26, v218, v186
    v_pk_mul_f16 v27, v219, v187
    v_smfmac_f32_16x16x64_bf16 v[136:139], v[112:115], v[36:43], v12
    ds_read_b128 v[228:231], v4 offset:4384
    s_waitcnt lgkmcnt(2)
    v_add_f32_e32 v18, v18, v132
    v_fmac_f32_e64 v19, v132, v133
    v_mfma_f32_16x16x32_f16 v[140:143], v[100:103], v[24:27], v[140:143]
    v_pk_mul_f16 v20, v220, v188
    v_pk_mul_f16 v21, v221, v189
    v_mfma_f32_32x32x16_f16 v[36:51], v[84:87], v[24:27], v[68:83]
    v_pk_mul_f16 v22, v222, v190
    v_pk_mul_f16 v23, v223, v191
    v_add_f32_e64 v52, |v52|, |v60|
    v_add_f32_e64 v53, |v53|, |v61|
    v_add_f32_e64 v54, |v54|, |v62|
    v_add_f32_e64 v55, |v55|, |v63|
    v_mfma_f32_32x32x16_f16 v[36:51], v[88:91], v[20:23], v[36:51]
    v_add_f32_e64 v56, |v56|, |v64|
    v_add_f32_e64 v57, |v57|, |v65|
    v_add_f32_e64 v58, |v58|, |v66|
    v_fma_f32 v59, |v59|, v118, |v67|
    v_pk_mul_f16 v24, v200, v176
    v_pk_mul_f16 v25, v201, v177
    v_mfma_f32_16x16x32_f16 v[140:143], v[104:107], v[20:23], v[140:143]
    v_pk_mul_f16 v26, v202, v178
    v_pk_mul_f16 v27, v203, v179
    v_smfmac_f32_16x16x64_bf16 v[140:143], v[108:111], v[52:59], v12
    ds_read_b128 v[192:195], v5 offset:2176
    s_waitcnt lgkmcnt(1)
    v_exp_f32_e32 v136, v136
    v_mfma_f32_16x16x32_f16 v[128:131], v[92:95], v[24:27], 0
    v_pk_mul_f16 v20, v204, v180
    v_pk_mul_f16 v21, v205, v181
    v_mfma_f32_32x32x16_f16 v[52:67], v[84:87], v[24:27], v[68:83]
    v_pk_mul_f16 v22, v206, v182
    v_pk_mul_f16 v23, v207, v183
    v_add_f32_e64 v36, |v36|, |v44|
    v_add_f32_e64 v37, |v37|, |v45|
    v_add_f32_e64 v38, |v38|, |v46|
    v_add_f32_e64 v39, |v39|, |v47|
    v_mfma_f32_32x32x16_f16 v[52:67], v[88:91], v[20:23], v[52:67]
    v_add_f32_e64 v40, |v40|, |v48|
    v_add_f32_e64 v41, |v41|, |v49|
    v_add_f32_e64 v42, |v42|, |v50|
    v_fma_f32 v43, |v43|, v118, |v51|
    v_pk_mul_f16 v24, v224, v248
    v_pk_mul_f16 v25, v225, v249
    v_mfma_f32_16x16x32_f16 v[128:131], v[96:99], v[20:23], v[128:131]
    v_pk_mul_f16 v26, v226, v250
    v_pk_mul_f16 v27, v227, v251
    v_smfmac_f32_16x16x64_bf16 v[140:143], v[112:115], v[36:43], v12
    ds_read_b128 v[196:199], v5 offset:2208
    v_add_f32_e64 v18, v18, v136
    v_fmac_f32_e64 v19, v136, v137
    v_mfma_f32_16x16x32_f16 v[128:131], v[100:103], v[24:27], v[128:131]
    v_pk_mul_f16 v20, v228, v252
    v_pk_mul_f16 v21, v229, v253
    v_mfma_f32_32x32x16_f16 v[36:51], v[84:87], v[24:27], v[68:83]
    v_pk_mul_f16 v22, v230, v254
    v_pk_mul_f16 v23, v231, v255
    v_add_f32_e64 v52, |v52|, |v60|
    v_add_f32_e64 v53, |v53|, |v61|
    v_add_f32_e64 v54, |v54|, |v62|
    v_add_f32_e64 v55, |v55|, |v63|
    v_mfma_f32_32x32x16_f16 v[36:51], v[88:91], v[20:23], v[36:51]
    v_add_f32_e64 v56, |v56|, |v64|
    v_add_f32_e64 v57, |v57|, |v65|
    v_add_f32_e64 v58, |v58|, |v66|
    v_fma_f32 v59, |v59|, v118, |v67|
    v_pk_mul_f16 v24, v224, v232
    v_pk_mul_f16 v25, v225, v233
    v_mfma_f32_16x16x32_f16 v[128:131], v[104:107], v[20:23], v[128:131]
    v_pk_mul_f16 v26, v226, v234
    v_pk_mul_f16 v27, v227, v235
    v_smfmac_f32_16x16x64_bf16 v[128:131], v[108:111], v[52:59], v12
    v_exp_f32_e64 v140, v140
    v_mfma_f32_16x16x32_f16 v[132:135], v[92:95], v[24:27], 0
    v_pk_mul_f16 v20, v228, v236
    v_pk_mul_f16 v21, v229, v237
    v_mfma_f32_32x32x16_f16 v[52:67], v[84:87], v[24:27], v[68:83]
    v_pk_mul_f16 v22, v230, v238
    v_pk_mul_f16 v23, v231, v239
    v_add_f32_e64 v36, |v36|, |v44|
    v_add_f32_e64 v37, |v37|, |v45|
    v_add_f32_e64 v38, |v38|, |v46|
    v_add_f32_e64 v39, |v39|, |v47|
    v_mfma_f32_32x32x16_f16 v[52:67], v[88:91], v[20:23], v[52:67]
    v_add_f32_e64 v40, |v40|, |v48|
    v_add_f32_e64 v41, |v41|, |v49|
    v_add_f32_e64 v42, |v42|, |v50|
    v_fma_f32 v43, |v43|, v118, |v51|
    v_pk_mul_f16 v24, v224, v240
    v_pk_mul_f16 v25, v225, v241
    v_mfma_f32_16x16x32_f16 v[132:135], v[96:99], v[20:23], v[132:135]
    v_pk_mul_f16 v26, v226, v242
    v_pk_mul_f16 v27, v227, v243
    v_smfmac_f32_16x16x64_bf16 v[128:131], v[112:115], v[36:43], v12
    s_waitcnt vmcnt(0)
    v_add_f32_e32 v18, v18, v140
    v_mfma_f32_16x16x32_f16 v[132:135], v[100:103], v[24:27], v[132:135]
    v_pk_mul_f16 v20, v228, v244
    v_pk_mul_f16 v21, v229, v245
    v_mfma_f32_32x32x16_f16 v[36:51], v[84:87], v[24:27], v[68:83]
    v_pk_mul_f16 v22, v230, v246
    v_pk_mul_f16 v23, v231, v247
    v_add_f32_e64 v52, |v52|, |v60|
    v_add_f32_e64 v53, |v53|, |v61|
    v_add_f32_e64 v54, |v54|, |v62|
    v_add_f32_e64 v55, |v55|, |v63|
    v_mfma_f32_32x32x16_f16 v[36:51], v[88:91], v[20:23], v[36:51]
    v_add_f32_e64 v56, |v56|, |v64|
    v_add_f32_e64 v57, |v57|, |v65|
    v_add_f32_e64 v58, |v58|, |v66|
    v_fma_f32 v59, |v59|, v118, |v67|
    v_pk_mul_f16 v24, v224, v208
    v_pk_mul_f16 v25, v225, v209
    v_mfma_f32_16x16x32_f16 v[132:135], v[104:107], v[20:23], v[132:135]
    v_pk_mul_f16 v26, v226, v210
    v_pk_mul_f16 v27, v227, v211
    v_mfma_f32_4x4x4_16b_bf16 v[120:123], v[116:117], v[144:145], 0
    v_fmac_f32_e64 v19, v140, v141
    v_mfma_f32_4x4x4_16b_bf16 v[124:127], v[116:117], v[146:147], 0
    v_exp_f32_e64 v128, v128
    v_smfmac_f32_16x16x64_bf16 v[132:135], v[108:111], v[52:59], v12
    v_add_f32_e64 v18, v18, v128
    v_cvt_pk_f16_f32 v120, v120, v121
    v_cvt_pk_f16_f32 v121, v122, v123
    v_cvt_pk_f16_f32 v122, v124, v125
    v_cvt_pk_f16_f32 v123, v126, v127
    v_mfma_f32_16x16x32_f16 v[136:139], v[92:95], v[24:27], 0
    ds_write_b128 v9, v[120:123] offset:5440
    v_pk_mul_f16 v20, v228, v212
    v_pk_mul_f16 v21, v229, v213
    v_mfma_f32_32x32x16_f16 v[52:67], v[84:87], v[24:27], v[68:83]
    v_pk_mul_f16 v22, v230, v214
    v_pk_mul_f16 v23, v231, v215
    v_add_f32_e64 v36, |v36|, |v44|
    v_add_f32_e64 v37, |v37|, |v45|
    v_add_f32_e64 v38, |v38|, |v46|
    v_add_f32_e64 v39, |v39|, |v47|
    v_mfma_f32_32x32x16_f16 v[52:67], v[88:91], v[20:23], v[52:67]
    v_add_f32_e64 v40, |v40|, |v48|
    v_add_f32_e64 v41, |v41|, |v49|
    v_add_f32_e64 v42, |v42|, |v50|
    v_fma_f32 v43, |v43|, v118, |v51|
    v_pk_mul_f16 v24, v224, v216
    v_pk_mul_f16 v25, v225, v217
    v_mfma_f32_16x16x32_f16 v[136:139], v[96:99], v[20:23], v[136:139]
    v_pk_mul_f16 v26, v226, v218
    v_pk_mul_f16 v27, v227, v219
    v_smfmac_f32_16x16x64_bf16 v[132:135], v[112:115], v[36:43], v12
    ds_read_b128 v[160:163], v4 offset:5440
    v_fmac_f32_e64 v19, v128, v129
    v_mfma_f32_16x16x32_f16 v[136:139], v[100:103], v[24:27], v[136:139]
    v_pk_mul_f16 v20, v228, v220
    v_pk_mul_f16 v21, v229, v221
    v_mfma_f32_32x32x16_f16 v[36:51], v[84:87], v[24:27], v[68:83]
    v_pk_mul_f16 v22, v230, v222
    v_pk_mul_f16 v23, v231, v223
    v_add_f32_e64 v52, |v52|, |v60|
    v_add_f32_e64 v53, |v53|, |v61|
    v_add_f32_e64 v54, |v54|, |v62|
    v_add_f32_e64 v55, |v55|, |v63|
    v_mfma_f32_32x32x16_f16 v[36:51], v[88:91], v[20:23], v[36:51]
    v_add_f32_e64 v56, |v56|, |v64|
    v_add_f32_e64 v57, |v57|, |v65|
    v_add_f32_e64 v58, |v58|, |v66|
    v_fma_f32 v59, |v59|, v118, |v67|
    v_pk_mul_f16 v24, v224, v168
    v_pk_mul_f16 v25, v225, v169
    v_mfma_f32_16x16x32_f16 v[136:139], v[104:107], v[20:23], v[136:139]
    v_pk_mul_f16 v26, v226, v170
    v_pk_mul_f16 v27, v227, v171
    v_smfmac_f32_16x16x64_bf16 v[136:139], v[108:111], v[52:59], v12
    ds_read_b128 v[164:167], v4 offset:5472
    v_exp_f32_e64 v132, v132
    v_mfma_f32_16x16x32_f16 v[140:143], v[92:95], v[24:27], 0
    v_pk_mul_f16 v20, v228, v172
    v_pk_mul_f16 v21, v229, v173
    v_mfma_f32_32x32x16_f16 v[52:67], v[84:87], v[24:27], v[68:83]
    v_pk_mul_f16 v22, v230, v174
    v_pk_mul_f16 v23, v231, v175
    v_add_f32_e64 v36, |v36|, |v44|
    v_add_f32_e64 v37, |v37|, |v45|
    v_add_f32_e64 v38, |v38|, |v46|
    v_add_f32_e64 v39, |v39|, |v47|
    v_mfma_f32_32x32x16_f16 v[52:67], v[88:91], v[20:23], v[52:67]
    v_add_f32_e64 v40, |v40|, |v48|
    v_add_f32_e64 v41, |v41|, |v49|
    v_add_f32_e64 v42, |v42|, |v50|
    v_fma_f32 v43, |v43|, v118, |v51|
    v_pk_mul_f16 v24, v224, v184
    v_pk_mul_f16 v25, v225, v185
    v_mfma_f32_16x16x32_f16 v[140:143], v[96:99], v[20:23], v[140:143]
    v_pk_mul_f16 v26, v226, v186
    v_pk_mul_f16 v27, v227, v187
    v_smfmac_f32_16x16x64_bf16 v[136:139], v[112:115], v[36:43], v12
    ds_read_b128 v[200:203], v1 offset:4352
    s_waitcnt lgkmcnt(2)
    v_add_f32_e32 v18, v18, v132
    v_fmac_f32_e64 v19, v132, v133
    v_mfma_f32_16x16x32_f16 v[140:143], v[100:103], v[24:27], v[140:143]
    v_pk_mul_f16 v20, v228, v188
    v_pk_mul_f16 v21, v229, v189
    v_mfma_f32_32x32x16_f16 v[36:51], v[84:87], v[24:27], v[68:83]
    v_pk_mul_f16 v22, v230, v190
    v_pk_mul_f16 v23, v231, v191
    v_add_f32_e64 v52, |v52|, |v60|
    v_add_f32_e64 v53, |v53|, |v61|
    v_add_f32_e64 v54, |v54|, |v62|
    v_add_f32_e64 v55, |v55|, |v63|
    v_mfma_f32_32x32x16_f16 v[36:51], v[88:91], v[20:23], v[36:51]
    v_add_f32_e64 v56, |v56|, |v64|
    v_add_f32_e64 v57, |v57|, |v65|
    v_add_f32_e64 v58, |v58|, |v66|
    v_fma_f32 v59, |v59|, v118, |v67|
    v_pk_mul_f16 v24, v224, v192
    v_pk_mul_f16 v25, v225, v193
    v_mfma_f32_16x16x32_f16 v[140:143], v[104:107], v[20:23], v[140:143]
    v_pk_mul_f16 v26, v226, v194
    v_pk_mul_f16 v27, v227, v195
    v_smfmac_f32_16x16x64_bf16 v[140:143], v[108:111], v[52:59], v12
    ds_read_b128 v[204:207], v1 offset:4384
    s_setprio 1
    s_waitcnt lgkmcnt(2)
    v_exp_f32_e64 v136, v136
    v_mfma_f32_16x16x32_f16 v[128:131], v[92:95], v[24:27], 0
    v_pk_mul_f16 v20, v228, v196
    v_pk_mul_f16 v21, v229, v197
    v_mfma_f32_32x32x16_f16 v[52:67], v[84:87], v[24:27], v[68:83]
    v_pk_mul_f16 v22, v230, v198
    v_pk_mul_f16 v23, v231, v199
    v_add_f32_e64 v36, |v36|, |v44|
    v_add_f32_e64 v37, |v37|, |v45|
    v_add_f32_e64 v38, |v38|, |v46|
    v_add_f32_e64 v39, |v39|, |v47|
    v_mfma_f32_32x32x16_f16 v[52:67], v[88:91], v[20:23], v[52:67]
    v_add_f32_e64 v40, |v40|, |v48|
    v_add_f32_e64 v41, |v41|, |v49|
    v_add_f32_e64 v42, |v42|, |v50|
    v_fma_f32 v43, |v43|, v118, |v51|
    v_pk_mul_f16 v24, v160, v232
    v_pk_mul_f16 v25, v161, v233
    v_mfma_f32_16x16x32_f16 v[128:131], v[96:99], v[20:23], v[128:131]
    v_pk_mul_f16 v26, v162, v234
    v_pk_mul_f16 v27, v163, v235
    v_smfmac_f32_16x16x64_bf16 v[140:143], v[112:115], v[36:43], v12
    ds_read_b128 v[176:179], v2 offset:4352
    v_add_f32_e64 v18, v18, v136
    v_fmac_f32_e64 v19, v136, v137
    v_mfma_f32_16x16x32_f16 v[128:131], v[100:103], v[24:27], v[128:131]
    v_pk_mul_f16 v20, v164, v236
    v_pk_mul_f16 v21, v165, v237
    v_mfma_f32_32x32x16_f16 v[36:51], v[84:87], v[24:27], v[68:83]
    v_pk_mul_f16 v22, v166, v238
    v_pk_mul_f16 v23, v167, v239
    v_add_f32_e64 v52, |v52|, |v60|
    v_add_f32_e64 v53, |v53|, |v61|
    v_add_f32_e64 v54, |v54|, |v62|
    v_add_f32_e64 v55, |v55|, |v63|
    v_mfma_f32_32x32x16_f16 v[36:51], v[88:91], v[20:23], v[36:51]
    v_add_f32_e64 v56, |v56|, |v64|
    v_add_f32_e64 v57, |v57|, |v65|
    v_add_f32_e64 v58, |v58|, |v66|
    v_fma_f32 v59, |v59|, v118, |v67|
    v_pk_mul_f16 v24, v160, v208
    v_pk_mul_f16 v25, v161, v209
    v_mfma_f32_16x16x32_f16 v[128:131], v[104:107], v[20:23], v[128:131]
    v_pk_mul_f16 v26, v162, v210
    v_pk_mul_f16 v27, v163, v211
    v_smfmac_f32_16x16x64_bf16 v[128:131], v[108:111], v[52:59], v12
    ds_read_b128 v[180:183], v2 offset:4384
    v_exp_f32_e64 v140, v140
    v_mfma_f32_16x16x32_f16 v[132:135], v[92:95], v[24:27], 0
    v_pk_mul_f16 v20, v164, v212
    v_pk_mul_f16 v21, v165, v213
    v_mfma_f32_32x32x16_f16 v[52:67], v[84:87], v[24:27], v[68:83]
    v_pk_mul_f16 v22, v166, v214
    v_pk_mul_f16 v23, v167, v215
    v_add_f32_e64 v36, |v36|, |v44|
    v_add_f32_e64 v37, |v37|, |v45|
    v_add_f32_e64 v38, |v38|, |v46|
    v_add_f32_e64 v39, |v39|, |v47|
    v_mfma_f32_32x32x16_f16 v[52:67], v[88:91], v[20:23], v[52:67]
    v_add_f32_e64 v40, |v40|, |v48|
    v_add_f32_e64 v41, |v41|, |v49|
    v_add_f32_e64 v42, |v42|, |v50|
    v_fma_f32 v43, |v43|, v118, |v51|
    v_pk_mul_f16 v24, v160, v240
    v_pk_mul_f16 v25, v161, v241
    v_mfma_f32_16x16x32_f16 v[132:135], v[96:99], v[20:23], v[132:135]
    v_pk_mul_f16 v26, v162, v242
    v_pk_mul_f16 v27, v163, v243
    v_smfmac_f32_16x16x64_bf16 v[128:131], v[112:115], v[36:43], v12
    ds_read_b128 v[224:227], v3 offset:4352
    v_add_f32_e64 v18, v18, v140
    v_fmac_f32_e64 v19, v140, v141
    v_mfma_f32_16x16x32_f16 v[132:135], v[100:103], v[24:27], v[132:135]
    v_pk_mul_f16 v20, v164, v244
    v_pk_mul_f16 v21, v165, v245
    v_mfma_f32_32x32x16_f16 v[36:51], v[84:87], v[24:27], v[68:83]
    v_pk_mul_f16 v22, v166, v246
    v_pk_mul_f16 v23, v167, v247
    v_add_f32_e64 v52, |v52|, |v60|
    v_add_f32_e64 v53, |v53|, |v61|
    v_add_f32_e64 v54, |v54|, |v62|
    v_add_f32_e64 v55, |v55|, |v63|
    v_mfma_f32_32x32x16_f16 v[36:51], v[88:91], v[20:23], v[36:51]
    v_add_f32_e64 v56, |v56|, |v64|
    v_add_f32_e64 v57, |v57|, |v65|
    v_add_f32_e64 v58, |v58|, |v66|
    v_fma_f32 v59, |v59|, v118, |v67|
    v_pk_mul_f16 v24, v160, v168
    v_pk_mul_f16 v25, v161, v169
    v_mfma_f32_16x16x32_f16 v[132:135], v[104:107], v[20:23], v[132:135]
    v_pk_mul_f16 v26, v162, v170
    v_pk_mul_f16 v27, v163, v171
    v_smfmac_f32_16x16x64_bf16 v[132:135], v[108:111], v[52:59], v12
    ds_read_b128 v[228:231], v3 offset:4384
    v_exp_f32_e64 v128, v128
    v_mfma_f32_16x16x32_f16 v[136:139], v[92:95], v[24:27], 0
    v_pk_mul_f16 v20, v164, v172
    v_pk_mul_f16 v21, v165, v173
    v_mfma_f32_32x32x16_f16 v[52:67], v[84:87], v[24:27], v[68:83]
    v_pk_mul_f16 v22, v166, v174
    v_pk_mul_f16 v23, v167, v175
    v_add_f32_e64 v36, |v36|, |v44|
    v_add_f32_e64 v37, |v37|, |v45|
    v_add_f32_e64 v38, |v38|, |v46|
    v_add_f32_e64 v39, |v39|, |v47|
    v_mfma_f32_32x32x16_f16 v[52:67], v[88:91], v[20:23], v[52:67]
    v_add_f32_e64 v40, |v40|, |v48|
    v_add_f32_e64 v41, |v41|, |v49|
    v_add_f32_e64 v42, |v42|, |v50|
    v_fma_f32 v43, |v43|, v118, |v51|
    v_pk_mul_f16 v24, v160, v192
    v_pk_mul_f16 v25, v161, v193
    v_mfma_f32_16x16x32_f16 v[136:139], v[96:99], v[20:23], v[136:139]
    v_pk_mul_f16 v26, v162, v194
    v_pk_mul_f16 v27, v163, v195
    v_smfmac_f32_16x16x64_bf16 v[132:135], v[112:115], v[36:43], v12
    ds_read_b128 v[232:235], v6 offset:7072
    v_add_f32_e64 v18, v18, v128
    v_fmac_f32_e64 v19, v128, v129
    v_mfma_f32_16x16x32_f16 v[136:139], v[100:103], v[24:27], v[136:139]
    v_pk_mul_f16 v20, v164, v196
    v_pk_mul_f16 v21, v165, v197
    v_mfma_f32_32x32x16_f16 v[36:51], v[84:87], v[24:27], v[68:83]
    v_pk_mul_f16 v22, v166, v198
    v_pk_mul_f16 v23, v167, v199
    v_add_f32_e64 v52, |v52|, |v60|
    v_add_f32_e64 v53, |v53|, |v61|
    v_add_f32_e64 v54, |v54|, |v62|
    v_add_f32_e64 v55, |v55|, |v63|
    v_mfma_f32_32x32x16_f16 v[36:51], v[88:91], v[20:23], v[36:51]
    v_add_f32_e64 v56, |v56|, |v64|
    v_add_f32_e64 v57, |v57|, |v65|
    v_add_f32_e64 v58, |v58|, |v66|
    v_fma_f32 v59, |v59|, v118, |v67|
    v_pk_mul_f16 v24, v160, v184
    v_pk_mul_f16 v25, v161, v185
    v_mfma_f32_16x16x32_f16 v[136:139], v[104:107], v[20:23], v[136:139]
    v_pk_mul_f16 v26, v162, v186
    v_pk_mul_f16 v27, v163, v187
    v_smfmac_f32_16x16x64_bf16 v[136:139], v[108:111], v[52:59], v12
    ds_read_b128 v[236:239], v6 offset:7104
    s_waitcnt lgkmcnt(2)
    v_exp_f32_e32 v132, v132
    v_mfma_f32_16x16x32_f16 v[140:143], v[92:95], v[24:27], 0
    v_pk_mul_f16 v20, v164, v188
    v_pk_mul_f16 v21, v165, v189
    v_mfma_f32_32x32x16_f16 v[52:67], v[84:87], v[24:27], v[68:83]
    v_pk_mul_f16 v22, v166, v190
    v_pk_mul_f16 v23, v167, v191
    v_add_f32_e64 v36, |v36|, |v44|
    v_add_f32_e64 v37, |v37|, |v45|
    v_add_f32_e64 v38, |v38|, |v46|
    v_add_f32_e64 v39, |v39|, |v47|
    v_mfma_f32_32x32x16_f16 v[52:67], v[88:91], v[20:23], v[52:67]
    v_add_f32_e64 v40, |v40|, |v48|
    v_add_f32_e64 v41, |v41|, |v49|
    v_add_f32_e64 v42, |v42|, |v50|
    v_fma_f32 v43, |v43|, v118, |v51|
    v_pk_mul_f16 v24, v200, v176
    v_pk_mul_f16 v25, v201, v177
    v_mfma_f32_16x16x32_f16 v[140:143], v[96:99], v[20:23], v[140:143]
    v_pk_mul_f16 v26, v202, v178
    v_pk_mul_f16 v27, v203, v179
    v_smfmac_f32_16x16x64_bf16 v[136:139], v[112:115], v[36:43], v12
    ds_read_b128 v[208:211], v6 offset:7344
    v_add_f32_e64 v18, v18, v132
    v_fmac_f32_e64 v19, v132, v133
    v_mfma_f32_16x16x32_f16 v[140:143], v[100:103], v[24:27], v[140:143]
    v_pk_mul_f16 v20, v204, v180
    v_pk_mul_f16 v21, v205, v181
    v_mfma_f32_32x32x16_f16 v[36:51], v[84:87], v[24:27], v[68:83]
    v_pk_mul_f16 v22, v206, v182
    v_pk_mul_f16 v23, v207, v183
    v_add_f32_e64 v52, |v52|, |v60|
    v_add_f32_e64 v53, |v53|, |v61|
    v_add_f32_e64 v54, |v54|, |v62|
    v_add_f32_e64 v55, |v55|, |v63|
    v_mfma_f32_32x32x16_f16 v[36:51], v[88:91], v[20:23], v[36:51]
    v_add_f32_e64 v56, |v56|, |v64|
    v_add_f32_e64 v57, |v57|, |v65|
    v_add_f32_e64 v58, |v58|, |v66|
    v_fma_f32 v59, |v59|, v118, |v67|
    v_pk_mul_f16 v24, v176, v224
    v_pk_mul_f16 v25, v177, v225
    v_mfma_f32_16x16x32_f16 v[140:143], v[104:107], v[20:23], v[140:143]
    v_pk_mul_f16 v26, v178, v226
    v_pk_mul_f16 v27, v179, v227
    v_smfmac_f32_16x16x64_bf16 v[140:143], v[108:111], v[52:59], v12
    ds_read_b128 v[212:215], v6 offset:7376
    v_exp_f32_e64 v136, v136
    v_mfma_f32_16x16x32_f16 v[128:131], v[92:95], v[24:27], 0
    v_pk_mul_f16 v20, v180, v228
    v_pk_mul_f16 v21, v181, v229
    v_mfma_f32_32x32x16_f16 v[52:67], v[84:87], v[24:27], v[68:83]
    v_pk_mul_f16 v22, v182, v230
    v_pk_mul_f16 v23, v183, v231
    v_add_f32_e64 v36, |v36|, |v44|
    v_add_f32_e64 v37, |v37|, |v45|
    v_add_f32_e64 v38, |v38|, |v46|
    v_add_f32_e64 v39, |v39|, |v47|
    v_mfma_f32_32x32x16_f16 v[52:67], v[88:91], v[20:23], v[52:67]
    v_add_f32_e64 v40, |v40|, |v48|
    v_add_f32_e64 v41, |v41|, |v49|
    v_add_f32_e64 v42, |v42|, |v50|
    v_fma_f32 v43, |v43|, v118, |v51|
    v_pk_mul_f16 v24, v200, v224
    v_pk_mul_f16 v25, v201, v225
    v_mfma_f32_16x16x32_f16 v[128:131], v[96:99], v[20:23], v[128:131]
    v_pk_mul_f16 v26, v202, v226
    v_pk_mul_f16 v27, v203, v227
    v_smfmac_f32_16x16x64_bf16 v[140:143], v[112:115], v[36:43], v12
    ds_read_b128 v[240:243], v7 offset:4352
    v_add_f32_e64 v18, v18, v136
    v_fmac_f32_e64 v19, v136, v137
    v_mfma_f32_16x16x32_f16 v[128:131], v[100:103], v[24:27], v[128:131]
    v_pk_mul_f16 v20, v204, v228
    v_pk_mul_f16 v21, v205, v229
    v_mfma_f32_32x32x16_f16 v[36:51], v[84:87], v[24:27], v[68:83]
    v_pk_mul_f16 v22, v206, v230
    v_pk_mul_f16 v23, v207, v231
    v_add_f32_e64 v52, |v52|, |v60|
    v_add_f32_e64 v53, |v53|, |v61|
    v_add_f32_e64 v54, |v54|, |v62|
    v_add_f32_e64 v55, |v55|, |v63|
    v_mfma_f32_32x32x16_f16 v[36:51], v[88:91], v[20:23], v[36:51]
    v_add_f32_e64 v56, |v56|, |v64|
    v_add_f32_e64 v57, |v57|, |v65|
    v_add_f32_e64 v58, |v58|, |v66|
    v_fma_f32 v59, |v59|, v118, |v67|
    v_pk_mul_f16 v24, v160, v248
    v_pk_mul_f16 v25, v161, v249
    v_mfma_f32_16x16x32_f16 v[128:131], v[104:107], v[20:23], v[128:131]
    v_pk_mul_f16 v26, v162, v250
    v_pk_mul_f16 v27, v163, v251
    v_smfmac_f32_16x16x64_bf16 v[128:131], v[108:111], v[52:59], v12
    ds_read_b128 v[244:247], v7 offset:4384
    v_exp_f32_e64 v140, v140
    v_mfma_f32_16x16x32_f16 v[132:135], v[92:95], v[24:27], 0
    v_pk_mul_f16 v20, v164, v252
    v_pk_mul_f16 v21, v165, v253
    v_mfma_f32_32x32x16_f16 v[52:67], v[84:87], v[24:27], v[68:83]
    v_pk_mul_f16 v22, v166, v254
    v_pk_mul_f16 v23, v167, v255
    v_add_f32_e64 v36, |v36|, |v44|
    v_add_f32_e64 v37, |v37|, |v45|
    v_add_f32_e64 v38, |v38|, |v46|
    v_add_f32_e64 v39, |v39|, |v47|
    v_mfma_f32_32x32x16_f16 v[52:67], v[88:91], v[20:23], v[52:67]
    v_add_f32_e64 v40, |v40|, |v48|
    v_add_f32_e64 v41, |v41|, |v49|
    v_add_f32_e64 v42, |v42|, |v50|
    v_fma_f32 v43, |v43|, v118, |v51|
    v_pk_mul_f16 v24, v160, v216
    v_pk_mul_f16 v25, v161, v217
    v_mfma_f32_16x16x32_f16 v[132:135], v[96:99], v[20:23], v[132:135]
    v_pk_mul_f16 v26, v162, v218
    v_pk_mul_f16 v27, v163, v219
    v_smfmac_f32_16x16x64_bf16 v[128:131], v[112:115], v[36:43], v12
    ds_read_b128 v[168:171], v8 offset:5440
    s_waitcnt lgkmcnt(2)
    v_add_f32_e32 v18, v18, v140
    v_fmac_f32_e64 v19, v140, v141
    v_mfma_f32_16x16x32_f16 v[132:135], v[100:103], v[24:27], v[132:135]
    v_pk_mul_f16 v20, v164, v220
    v_pk_mul_f16 v21, v165, v221
    v_mfma_f32_32x32x16_f16 v[36:51], v[84:87], v[24:27], v[68:83]
    v_pk_mul_f16 v22, v166, v222
    v_pk_mul_f16 v23, v167, v223
    v_add_f32_e64 v52, |v52|, |v60|
    v_add_f32_e64 v53, |v53|, |v61|
    v_add_f32_e64 v54, |v54|, |v62|
    v_add_f32_e64 v55, |v55|, |v63|
    v_mfma_f32_32x32x16_f16 v[36:51], v[88:91], v[20:23], v[36:51]
    v_add_f32_e64 v56, |v56|, |v64|
    v_add_f32_e64 v57, |v57|, |v65|
    v_add_f32_e64 v58, |v58|, |v66|
    v_fma_f32 v59, |v59|, v118, |v67|
    v_pk_mul_f16 v24, v232, v248
    v_pk_mul_f16 v25, v233, v249
    v_mfma_f32_16x16x32_f16 v[132:135], v[104:107], v[20:23], v[132:135]
    v_pk_mul_f16 v26, v234, v250
    v_pk_mul_f16 v27, v235, v251
    v_smfmac_f32_16x16x64_bf16 v[132:135], v[108:111], v[52:59], v12
    ds_read_b128 v[172:175], v8 offset:5472
    v_exp_f32_e64 v128, v128
    v_mfma_f32_16x16x32_f16 v[136:139], v[92:95], v[24:27], 0
    v_pk_mul_f16 v20, v236, v252
    v_pk_mul_f16 v21, v237, v253
    v_mfma_f32_32x32x16_f16 v[52:67], v[84:87], v[24:27], v[68:83]
    v_pk_mul_f16 v22, v238, v254
    v_pk_mul_f16 v23, v239, v255
    v_add_f32_e64 v36, |v36|, |v44|
    v_add_f32_e64 v37, |v37|, |v45|
    v_add_f32_e64 v38, |v38|, |v46|
    v_add_f32_e64 v39, |v39|, |v47|
    v_mfma_f32_32x32x16_f16 v[52:67], v[88:91], v[20:23], v[52:67]
    v_add_f32_e64 v40, |v40|, |v48|
    v_add_f32_e64 v41, |v41|, |v49|
    v_add_f32_e64 v42, |v42|, |v50|
    v_fma_f32 v43, |v43|, v118, |v51|
    v_pk_mul_f16 v24, v208, v248
    v_pk_mul_f16 v25, v209, v249
    v_mfma_f32_16x16x32_f16 v[136:139], v[96:99], v[20:23], v[136:139]
    v_pk_mul_f16 v26, v210, v250
    v_pk_mul_f16 v27, v211, v251
    v_smfmac_f32_16x16x64_bf16 v[132:135], v[112:115], v[36:43], v12
    v_add_f32_e64 v18, v18, v128
    v_fmac_f32_e64 v19, v128, v129
    v_mfma_f32_16x16x32_f16 v[136:139], v[100:103], v[24:27], v[136:139]
    v_pk_mul_f16 v20, v212, v252
    v_pk_mul_f16 v21, v213, v253
    v_mfma_f32_32x32x16_f16 v[36:51], v[84:87], v[24:27], v[68:83]
    v_pk_mul_f16 v22, v214, v254
    v_pk_mul_f16 v23, v215, v255
    v_add_f32_e64 v52, |v52|, |v60|
    v_add_f32_e64 v53, |v53|, |v61|
    v_add_f32_e64 v54, |v54|, |v62|
    v_add_f32_e64 v55, |v55|, |v63|
    v_mfma_f32_32x32x16_f16 v[36:51], v[88:91], v[20:23], v[36:51]
    v_add_f32_e64 v56, |v56|, |v64|
    v_add_f32_e64 v57, |v57|, |v65|
    v_add_f32_e64 v58, |v58|, |v66|
    v_fma_f32 v59, |v59|, v118, |v67|
    v_pk_mul_f16 v24, v232, v216
    v_pk_mul_f16 v25, v233, v217
    v_mfma_f32_16x16x32_f16 v[136:139], v[104:107], v[20:23], v[136:139]
    v_pk_mul_f16 v26, v234, v218
    v_pk_mul_f16 v27, v235, v219
    v_smfmac_f32_16x16x64_bf16 v[136:139], v[108:111], v[52:59], v12
    v_exp_f32_e64 v132, v132
    v_mfma_f32_16x16x32_f16 v[140:143], v[92:95], v[24:27], 0
    v_pk_mul_f16 v20, v236, v220
    v_pk_mul_f16 v21, v237, v221
    v_mfma_f32_32x32x16_f16 v[52:67], v[84:87], v[24:27], v[68:83]
    v_pk_mul_f16 v22, v238, v222
    v_pk_mul_f16 v23, v239, v223
    v_add_f32_e64 v36, |v36|, |v44|
    v_add_f32_e64 v37, |v37|, |v45|
    v_add_f32_e64 v38, |v38|, |v46|
    v_add_f32_e64 v39, |v39|, |v47|
    v_mfma_f32_32x32x16_f16 v[52:67], v[88:91], v[20:23], v[52:67]
    v_add_f32_e64 v40, |v40|, |v48|
    v_add_f32_e64 v41, |v41|, |v49|
    v_add_f32_e64 v42, |v42|, |v50|
    v_fma_f32 v43, |v43|, v118, |v51|
    v_pk_mul_f16 v24, v208, v216
    v_pk_mul_f16 v25, v209, v217
    v_mfma_f32_16x16x32_f16 v[140:143], v[96:99], v[20:23], v[140:143]
    v_pk_mul_f16 v26, v210, v218
    v_pk_mul_f16 v27, v211, v219
    v_smfmac_f32_16x16x64_bf16 v[136:139], v[112:115], v[36:43], v12
    v_add_f32_e64 v18, v18, v132
    v_fmac_f32_e64 v19, v132, v133
    v_mfma_f32_16x16x32_f16 v[140:143], v[100:103], v[24:27], v[140:143]
    v_pk_mul_f16 v20, v212, v220
    v_pk_mul_f16 v21, v213, v221
    v_mfma_f32_32x32x16_f16 v[36:51], v[84:87], v[24:27], v[68:83]
    v_pk_mul_f16 v22, v214, v222
    v_pk_mul_f16 v23, v215, v223
    v_add_f32_e64 v52, |v52|, |v60|
    v_add_f32_e64 v53, |v53|, |v61|
    v_add_f32_e64 v54, |v54|, |v62|
    v_add_f32_e64 v55, |v55|, |v63|
    v_mfma_f32_32x32x16_f16 v[36:51], v[88:91], v[20:23], v[36:51]
    v_add_f32_e64 v56, |v56|, |v64|
    v_add_f32_e64 v57, |v57|, |v65|
    v_add_f32_e64 v58, |v58|, |v66|
    v_fma_f32 v59, |v59|, v118, |v67|
    v_pk_mul_f16 v24, v232, v200
    v_pk_mul_f16 v25, v233, v201
    v_mfma_f32_16x16x32_f16 v[140:143], v[104:107], v[20:23], v[140:143]
    v_pk_mul_f16 v26, v234, v202
    v_pk_mul_f16 v27, v235, v203
    v_smfmac_f32_16x16x64_bf16 v[140:143], v[108:111], v[52:59], v12
    v_exp_f32_e64 v136, v136
    v_mfma_f32_16x16x32_f16 v[128:131], v[92:95], v[24:27], 0
    v_pk_mul_f16 v20, v236, v204
    v_pk_mul_f16 v21, v237, v205
    v_mfma_f32_32x32x16_f16 v[52:67], v[84:87], v[24:27], v[68:83]
    v_pk_mul_f16 v22, v238, v206
    v_pk_mul_f16 v23, v239, v207
    v_add_f32_e64 v36, |v36|, |v44|
    v_add_f32_e64 v37, |v37|, |v45|
    v_add_f32_e64 v38, |v38|, |v46|
    v_add_f32_e64 v39, |v39|, |v47|
    v_mfma_f32_32x32x16_f16 v[52:67], v[88:91], v[20:23], v[52:67]
    v_add_f32_e64 v40, |v40|, |v48|
    v_add_f32_e64 v41, |v41|, |v49|
    v_add_f32_e64 v42, |v42|, |v50|
    v_fma_f32 v43, |v43|, v118, |v51|
    v_pk_mul_f16 v24, v208, v200
    v_pk_mul_f16 v25, v209, v201
    v_mfma_f32_16x16x32_f16 v[128:131], v[96:99], v[20:23], v[128:131]
    v_pk_mul_f16 v26, v210, v202
    v_pk_mul_f16 v27, v211, v203
    v_smfmac_f32_16x16x64_bf16 v[140:143], v[112:115], v[36:43], v12
    s_waitcnt lgkmcnt(0)
    v_add_f32_e32 v18, v18, v136
    v_fmac_f32_e64 v19, v136, v137
    v_mfma_f32_16x16x32_f16 v[128:131], v[100:103], v[24:27], v[128:131]
    v_pk_mul_f16 v20, v212, v204
    v_pk_mul_f16 v21, v213, v205
    v_mfma_f32_32x32x16_f16 v[36:51], v[84:87], v[24:27], v[68:83]
    v_pk_mul_f16 v22, v214, v206
    v_pk_mul_f16 v23, v215, v207
    v_add_f32_e64 v52, |v52|, |v60|
    v_add_f32_e64 v53, |v53|, |v61|
    v_add_f32_e64 v54, |v54|, |v62|
    v_add_f32_e64 v55, |v55|, |v63|
    v_mfma_f32_32x32x16_f16 v[36:51], v[88:91], v[20:23], v[36:51]
    v_add_f32_e64 v56, |v56|, |v64|
    v_add_f32_e64 v57, |v57|, |v65|
    v_add_f32_e64 v58, |v58|, |v66|
    v_fma_f32 v59, |v59|, v118, |v67|
    v_pk_mul_f16 v24, v240, v168
    v_pk_mul_f16 v25, v241, v169
    v_mfma_f32_16x16x32_f16 v[128:131], v[104:107], v[20:23], v[128:131]
    v_pk_mul_f16 v26, v242, v170
    v_pk_mul_f16 v27, v243, v171
    v_smfmac_f32_16x16x64_bf16 v[128:131], v[108:111], v[52:59], v12
    s_setprio 0
    v_exp_f32_e32 v140, v140
    v_mfma_f32_16x16x32_f16 v[132:135], v[92:95], v[24:27], 0
    v_pk_mul_f16 v20, v244, v172
    v_pk_mul_f16 v21, v245, v173
    v_mfma_f32_32x32x16_f16 v[52:67], v[84:87], v[24:27], v[68:83]
    v_pk_mul_f16 v22, v246, v174
    v_pk_mul_f16 v23, v247, v175
    v_add_f32_e64 v36, |v36|, |v44|
    v_add_f32_e64 v37, |v37|, |v45|
    v_add_f32_e64 v38, |v38|, |v46|
    v_add_f32_e64 v39, |v39|, |v47|
    v_mfma_f32_32x32x16_f16 v[52:67], v[88:91], v[20:23], v[52:67]
    v_add_f32_e64 v40, |v40|, |v48|
    v_add_f32_e64 v41, |v41|, |v49|
    v_add_f32_e64 v42, |v42|, |v50|
    v_fma_f32 v43, |v43|, v118, |v51|
    v_mfma_f32_16x16x32_f16 v[132:135], v[96:99], v[20:23], v[132:135]
    s_nop 0
    v_smfmac_f32_16x16x64_bf16 v[128:131], v[112:115], v[36:43], v12
    v_add_f32_e64 v18, v18, v140
    v_fmac_f32_e64 v19, v140, v141
    s_nop 2
    v_add_f32_e64 v52, |v52|, |v60|
    v_add_f32_e64 v53, |v53|, |v61|
    v_add_f32_e64 v54, |v54|, |v62|
    v_add_f32_e64 v55, |v55|, |v63|
    v_add_f32_e64 v56, |v56|, |v64|
    v_add_f32_e64 v57, |v57|, |v65|
    v_add_f32_e64 v58, |v58|, |v66|
    v_fma_f32 v59, |v59|, v118, |v67|
    s_nop 1
    v_smfmac_f32_16x16x64_bf16 v[132:135], v[28:31], v[52:59], v12
    v_exp_f32_e64 v128, v128
    s_nop 0
    v_add_f32_e64 v18, v18, v128
    v_fmac_f32_e64 v19, v128, v129
    s_nop 3
    v_add_f32_e64 v132, v132, v119
    v_exp_f32_e64 v132, v132
    v_cmp_gt_f32_e64 s[52:53], s29, v133
    v_add_f32_e64 v18, v18, v132
    v_fmac_f32_e64 v19, v132, v133
    s_nop 0
    v_permlane32_swap_b32 v16, v18
    v_permlane32_swap_b32 v17, v19
    v_add_f32 v1, v16, v18
    v_add_f32 v2, v17, v19
    v_bfe_u32 v4, v0, 2, 4
    v_mul_f32 v3, s30, v2
    v_permlane16_swap_b32 v1, v2
    v_add_f32 v1, v1, v2
    v_lshrrev_b32 v5, 3, v10
    s_lshl_b32 s43, s3, 4
    v_add_f32_dpp v1, v1, v1 row_ror:4 row_mask:0xf bank_mask:0xf
    v_add3_u32 v4, v4, v5, s43
    s_movk_i32 s44, 0x1f8
    v_add_f32_dpp v2, v1, v1 row_ror:8 row_mask:0xf bank_mask:0xf
    v_add_f32_dpp v1, v1, v1 row_ror:8 row_mask:0xf bank_mask:0xf
    s_mov_b32 s45, 0xd800000
    s_mov_b32 s46, 0x6e000000
    v_permlane16_swap_b32 v1, v2
    v_rcp_f32 v5, v1
    v_cmp_ge_f32_e64 s[40:41], |v3|, v1
    v_mul_f32 v2, v2, v5
    s_mov_b32 exec_lo, 15
    v_ldexp_f32 v2, v2, v15
    s_mov_b32 exec_hi, 15
    v_cvt_pk_bf16_f32 v5, v2, v2
    buffer_store_short v5, v4, s[24:27], 0 offen
    v_subrev_u32 v1, s45, v1
    v_cmp_class_f32_e64 vcc, v2, s44
    v_cmp_gt_u32_e64 s[42:43], s46, v1
    s_lshr_b64 s[48:49], s[40:41], 16
    s_or_b64 s[40:41], s[40:41], s[48:49]
    s_lshr_b64 s[48:49], s[40:41], 8
    s_or_b64 s[40:41], s[40:41], s[48:49]
    s_lshr_b64 s[48:49], s[40:41], 4
    s_or_b64 s[40:41], s[40:41], s[48:49]
    s_or_b32 s32, s32, s33
    s_or_b32 s33, s34, s35
    s_lshr_b64 s[48:49], s[32:33], 16
    s_or_b64 s[32:33], s[32:33], s[48:49]
    s_lshr_b64 s[48:49], s[32:33], 8
    s_or_b64 s[32:33], s[32:33], s[48:49]
    s_lshr_b64 s[48:49], s[32:33], 4
    s_or_b64 s[32:33], s[32:33], s[48:49]
    s_and_b64 s[40:41], s[40:41], s[32:33]
    s_mov_b32 s52, s51
    s_lshr_b64 s[48:49], s[52:53], 8
    s_or_b64 s[52:53], s[52:53], s[48:49]
    s_lshr_b64 s[48:49], s[52:53], 4
    s_or_b64 s[52:53], s[52:53], s[48:49]
    s_and_b64 s[42:43], s[42:43], vcc
    s_and_b64 s[40:41], s[40:41], s[52:53]
    s_and_b64 s[40:41], s[40:41], s[42:43]
    s_andn2_b64 s[40:41], exec, s[40:41]
    s_cbranch_scc0 L_end
    s_lshl_b32 s41, s41, 4
    s_or_b32 s40, s40, s41
    s_mov_b64 exec, -1
    s_load_dwordx8 s[8:15], s[0:1], 32
    v_and_b32 v1, 31, v0
    v_bfe_u32 v2, v0, 5, 1
    v_min_u32 v3, 25, v1
    v_lshlrev_b32 v4, 3, v2
    v_lshlrev_b32 v5, 1, v1
    v_lshlrev_b32 v6, 1, v2
    s_waitcnt lgkmcnt(0)
    global_load_ushort v32, v4, s[12:13] offset:0
    global_load_ushort v33, v4, s[12:13] offset:2
    global_load_ushort v34, v4, s[12:13] offset:4
    global_load_ushort v35, v4, s[12:13] offset:6
    global_load_ushort v36, v4, s[12:13] offset:16
    global_load_ushort v37, v4, s[12:13] offset:18
    global_load_ushort v38, v4, s[12:13] offset:20
    global_load_ushort v39, v4, s[12:13] offset:22
    global_load_ushort v40, v4, s[12:13] offset:32
    global_load_ushort v41, v4, s[12:13] offset:34
    global_load_ushort v42, v4, s[12:13] offset:36
    global_load_ushort v43, v4, s[12:13] offset:38
    global_load_ushort v44, v4, s[12:13] offset:48
    global_load_ushort v45, v4, s[12:13] offset:50
    global_load_ushort v46, v4, s[12:13] offset:52
    global_load_ushort v47, v4, s[12:13] offset:54
    global_load_ushort v7, v5, s[10:11]
    v_cvt_f32_u32 v8, v2
    v_sub_f32 v8, 1.0, v8
    s_waitcnt vmcnt(0)
    v_lshlrev_b32 v32, 16, v32
    v_lshlrev_b32 v33, 16, v33
    v_lshlrev_b32 v34, 16, v34
    v_lshlrev_b32 v35, 16, v35
    v_lshlrev_b32 v36, 16, v36
    v_lshlrev_b32 v37, 16, v37
    v_lshlrev_b32 v38, 16, v38
    v_lshlrev_b32 v39, 16, v39
    v_lshlrev_b32 v40, 16, v40
    v_lshlrev_b32 v41, 16, v41
    v_lshlrev_b32 v42, 16, v42
    v_lshlrev_b32 v43, 16, v43
    v_lshlrev_b32 v44, 16, v44
    v_lshlrev_b32 v45, 16, v45
    v_lshlrev_b32 v46, 16, v46
    v_lshlrev_b32 v47, 16, v47
    s_mov_b32 exec_lo, 0
    v_mov_b32 v7, 0
    s_mov_b32 exec_lo, -1
    v_lshlrev_b32 v7, 16, v7
L_samp:
    s_ff1_i32_b32 s42, s40
    s_bitset0_b32 s40, s42
    s_lshl_b32 s43, s3, 3
    s_add_u32 s43, s43, s42
    s_mul_i32 s44, s43, 104
    v_mov_b32 v10, 0xff7fffff
    v_mov_b32 v11, 0
    v_mov_b32 v12, 0
    s_mov_b32 s45, 1
L_delta:
    v_add_u32 v13, s45, v3
    v_subrev_u32 v14, 26, v13
    v_min_u32 v13, v13, v14
    v_lshl_add_u32 v13, v13, 2, s44
    v_lshl_add_u32 v14, v3, 2, s44
    global_load_dword v13, v13, s[4:5]
    global_load_dword v14, v14, s[4:5]
    v_mfma_f32_32x32x2_f32 v[48:63], v7, v8, 0
    v_lshl_add_u32 v15, v2, 6, v5
    v_mov_b32 v16, v6
    v_mov_b32 v17, 0
    s_mov_b32 s46, 0
    s_waitcnt vmcnt(1)
    v_lshl_add_u32 v13, v13, 6, v6
    s_waitcnt vmcnt(0)
    v_lshl_add_u32 v14, v14, 6, v6
L_d:
    buffer_load_ushort v18, v13, s[20:23], s46 offen
    buffer_load_ushort v19, v14, s[20:23], s46 offen
    global_load_ushort v20, v15, s[8:9]
    global_load_ushort v21, v16, s[14:15]
    v_add_u32 v15, 128, v15
    v_add_u32 v16, 4, v16
    s_add_u32 s46, s46, 4
    s_waitcnt vmcnt(0)
    v_lshlrev_b32 v18, 16, v18
    v_lshlrev_b32 v19, 16, v19
    v_lshlrev_b32 v20, 16, v20
    v_lshlrev_b32 v21, 16, v21
    v_mul_f32 v18, v18, v19
    s_cmp_lt_u32 s46, 64
    v_fmac_f32 v17, v18, v21
    v_mfma_f32_32x32x2_f32 v[48:63], v20, v18, v[48:63]
    s_cbranch_scc1 L_d
    s_nop 15
    s_nop 3
    v_mov_b32 v18, 0
    v_add_f32_e64 v48, v48, |v48|
    v_fmac_f32 v18, v48, v32
    v_add_f32_e64 v49, v49, |v49|
    v_fmac_f32 v18, v49, v33
    v_add_f32_e64 v50, v50, |v50|
    v_fmac_f32 v18, v50, v34
    v_add_f32_e64 v51, v51, |v51|
    v_fmac_f32 v18, v51, v35
    v_add_f32_e64 v52, v52, |v52|
    v_fmac_f32 v18, v52, v36
    v_add_f32_e64 v53, v53, |v53|
    v_fmac_f32 v18, v53, v37
    v_add_f32_e64 v54, v54, |v54|
    v_fmac_f32 v18, v54, v38
    v_add_f32_e64 v55, v55, |v55|
    v_fmac_f32 v18, v55, v39
    v_add_f32_e64 v56, v56, |v56|
    v_fmac_f32 v18, v56, v40
    v_add_f32_e64 v57, v57, |v57|
    v_fmac_f32 v18, v57, v41
    v_add_f32_e64 v58, v58, |v58|
    v_fmac_f32 v18, v58, v42
    v_add_f32_e64 v59, v59, |v59|
    v_fmac_f32 v18, v59, v43
    v_add_f32_e64 v60, v60, |v60|
    v_fmac_f32 v18, v60, v44
    v_add_f32_e64 v61, v61, |v61|
    v_fmac_f32 v18, v61, v45
    v_add_f32_e64 v62, v62, |v62|
    v_fmac_f32 v18, v62, v46
    v_add_f32_e64 v63, v63, |v63|
    v_fmac_f32 v18, v63, v47
    v_mov_b32 v19, v18
    v_mov_b32 v20, v17
    s_cmp_eq_u32 s45, 13
    s_cselect_b32 s46, 13, 26
    v_permlane32_swap_b32 v18, v19
    v_permlane32_swap_b32 v17, v20
    v_add_f32 v18, v18, v19
    v_add_f32 v17, v17, v20
    v_mul_f32 v18, 0.5, v18
    v_cmp_gt_u32_e64 vcc, s46, v1
    s_nop 1
    s_mov_b64 exec, vcc
    v_max_f32 v19, v10, v18
    v_sub_f32 v20, v10, v19
    v_sub_f32 v18, v18, v19
    v_mul_f32 v20, 0x3fb8aa3b, v20
    v_mul_f32 v18, 0x3fb8aa3b, v18
    v_exp_f32 v20, v20
    v_exp_f32 v18, v18
    v_mov_b32 v10, v19
    v_mul_f32 v12, v12, v20
    v_fma_f32 v11, v11, v20, v18
    v_fmac_f32 v12, v18, v17
    s_mov_b64 exec, -1
    s_add_u32 s45, s45, 1
    s_cmp_le_u32 s45, 13
    s_cbranch_scc1 L_delta
    v_mov_b32 v13, v10
    s_nop 1
    v_max_f32_dpp v13, v13, v13 row_ror:1 row_mask:0xf bank_mask:0xf
    s_nop 1
    v_max_f32_dpp v13, v13, v13 row_ror:2 row_mask:0xf bank_mask:0xf
    s_nop 1
    v_max_f32_dpp v13, v13, v13 row_ror:4 row_mask:0xf bank_mask:0xf
    s_nop 1
    v_max_f32_dpp v13, v13, v13 row_ror:8 row_mask:0xf bank_mask:0xf
    v_mov_b32 v14, v13
    s_nop 1
    v_permlane16_swap_b32 v13, v14
    v_max_f32 v13, v13, v14
    v_sub_f32 v10, v10, v13
    v_mul_f32 v10, 0x3fb8aa3b, v10
    v_exp_f32 v10, v10
    s_nop 0
    v_mul_f32 v11, v11, v10
    v_mul_f32 v12, v12, v10
    s_nop 0
    v_add_f32_dpp v11, v11, v11 row_ror:1 row_mask:0xf bank_mask:0xf
    s_nop 1
    v_add_f32_dpp v11, v11, v11 row_ror:2 row_mask:0xf bank_mask:0xf
    s_nop 1
    v_add_f32_dpp v11, v11, v11 row_ror:4 row_mask:0xf bank_mask:0xf
    s_nop 1
    v_add_f32_dpp v11, v11, v11 row_ror:8 row_mask:0xf bank_mask:0xf
    v_mov_b32 v14, v11
    s_nop 1
    v_permlane16_swap_b32 v11, v14
    v_add_f32 v11, v11, v14
    v_add_f32_dpp v12, v12, v12 row_ror:1 row_mask:0xf bank_mask:0xf
    s_nop 1
    v_add_f32_dpp v12, v12, v12 row_ror:2 row_mask:0xf bank_mask:0xf
    s_nop 1
    v_add_f32_dpp v12, v12, v12 row_ror:4 row_mask:0xf bank_mask:0xf
    s_nop 1
    v_add_f32_dpp v12, v12, v12 row_ror:8 row_mask:0xf bank_mask:0xf
    v_mov_b32 v14, v12
    s_nop 1
    v_permlane16_swap_b32 v12, v14
    v_add_f32 v12, v12, v14
    v_rcp_f32 v11, v11
    s_lshl_b32 s43, s43, 1
    v_mov_b32 v13, s43
    v_mul_f32 v12, v12, v11
    v_cvt_pk_bf16_f32 v12, v12, v12
    s_mov_b64 exec, 1
    buffer_store_short v12, v13, s[24:27], 0 offen
    s_mov_b64 exec, -1
    s_cmp_lg_u32 s40, 0
    s_cbranch_scc1 L_samp
L_end:
    s_endpgm
.section .rodata,"a"
.p2align 6
.amdhsa_kernel standalone__factorization_afm__recsys_kernel
  .amdhsa_next_free_vgpr 256
  .amdhsa_next_free_sgpr 96
  .amdhsa_accum_offset 256
  .amdhsa_group_segment_fixed_size 0
  .amdhsa_kernarg_size 88
  .amdhsa_user_sgpr_count 2
  .amdhsa_user_sgpr_kernarg_segment_ptr 1
  .amdhsa_system_sgpr_workgroup_id_x 1
.end_amdhsa_kernel
```
